```python
import torch

def _softmax(x, axis=-1):
    return torch.softmax(x, dim=axis)
def _gelu(x):
    return torch.nn.functional.gelu(x, approximate="tanh")
def _silu(x):
    return torch.nn.functional.silu(x)
def _sigmoid(x):
    return torch.sigmoid(x)
def _layernorm(x, axis=-1, eps=1e-5):
    m = x.mean(dim=axis, keepdim=True)
    v = x.var(dim=axis, keepdim=True, unbiased=False)
    return (x - m) / torch.sqrt(v + eps)
def _scatter_add(tgt, idx, src, axis=0):
    return tgt.clone().index_add_(axis, idx, src)
def _segment_sum(src, seg, n):
    out = torch.zeros((n,) + src.shape[1:], dtype=src.dtype)
    return out.index_add_(0, seg, src)
def _pad(x, pw):
    flat = tuple(v for pair in reversed(pw) for v in pair)
    return torch.nn.functional.pad(x, flat)

kernel_name = 'parallel_sum__grouped_kv_mqa__glu_gated_swiglu__prompt'

def setup_inputs():

    _w = (lambda a: (lambda t: t.to(torch.bfloat16) if t.is_floating_point() else t)(torch.as_tensor(a)))
    def _A_setup():
        B, S, D, H = 1, 2048, 448, 16
        Dh = D // H
        return {
            "x": _w((lambda *s: torch.randn(*s, dtype=torch.bfloat16) * 0.05)(B, S, D)),
            "wq": _w((lambda *s: torch.randn(*s, dtype=torch.bfloat16) * 0.05)(D, H * Dh)),
            "wk": _w((lambda *s: torch.randn(*s, dtype=torch.bfloat16) * 0.05)(D, Dh)),
            "wv": _w((lambda *s: torch.randn(*s, dtype=torch.bfloat16) * 0.05)(D, Dh)),
            "wo": _w((lambda *s: torch.randn(*s, dtype=torch.bfloat16) * 0.05)(H * Dh, D)),
        }
    _A_in = _A_setup()

    def _B_setup():
        B, S, D, F = 1, 2048, 448, 1792
        return {
            "x": _w((lambda *s: torch.randn(*s, dtype=torch.bfloat16) * 0.05)(B, S, D)),
            "w1": _w((lambda *s: torch.randn(*s, dtype=torch.bfloat16) * 0.4)(D, F) * (2.0 / D) ** 0.5),
            "w3": _w((lambda *s: torch.randn(*s, dtype=torch.bfloat16) * 0.4)(D, F) * (2.0 / D) ** 0.5),
            "w2": _w((lambda *s: torch.randn(*s, dtype=torch.bfloat16) * 0.4)(F, D) * (2.0 / F) ** 0.5),
        }
    _B_in = _B_setup()

    return {
        "A_x": _A_in["x"],
        "A_wq": _A_in["wq"],
        "A_wk": _A_in["wk"],
        "A_wv": _A_in["wv"],
        "A_wo": _A_in["wo"],
        "B_x": _B_in["x"],
        "B_w1": _B_in["w1"],
        "B_w3": _B_in["w3"],
        "B_w2": _B_in["w2"],
    }

def reference(A_x, A_wq, A_wk, A_wv, A_wo, B_x, B_w1, B_w3, B_w2):
    def _A_ref(x, wq, wk, wv, wo):
        B, S, D = x.shape
        H = 16
        Dh = D // H
        q = (lambda x, *d: x.permute(*d))((x @ wq).reshape(B, S, H, Dh), 0, 2, 1, 3)
        k = x @ wk
        v = x @ wv
        scores = torch.einsum("bhqd,bkd->bhqk", q, k) * (Dh ** -0.5)
        p = _softmax(scores, axis=-1)
        o = torch.einsum("bhqk,bkd->bhqd", p, v)
        return (lambda x, *d: x.permute(*d))(o, 0, 2, 1, 3).reshape(B, S, H * Dh) @ wo

    def _B_ref(x, w1, w3, w2):
        gate = torch.einsum("bsd,df->bsf", x, w1)
        up = torch.einsum("bsd,df->bsf", x, w3)
        h = _silu(gate) * up
        out = torch.einsum("bsf,fd->bsd", h, w2)
        return out

    x = A_x
    xn = _layernorm(x, axis=-1)
    return x + _A_ref(xn, A_wq, A_wk, A_wv, A_wo) + _B_ref(xn, B_w1, B_w3, B_w2)
```

```asm
; @launch grid=(256,1,1) block=(512,1,1) lds=163840
.amdgcn_target "amdgcn-amd-amdhsa--gfx950"
.text
.globl parallel_sum__grouped_kv_mqa__glu_gated_swiglu__prompt_kernel
.p2align 8
.type parallel_sum__grouped_kv_mqa__glu_gated_swiglu__prompt_kernel,@function
parallel_sum__grouped_kv_mqa__glu_gated_swiglu__prompt_kernel:
    s_load_dwordx16 s[4:19], s[0:1], 0
    s_load_dwordx8 s[20:27], s[0:1], 64
    s_cmp_ge_u32 s2, 256
    s_cbranch_scc1 L_end
    v_and_b32 v1, 63, v0
    v_lshrrev_b32 v2, 6, v0
    s_lshr_b32 s70, s2, 5
    v_readfirstlane_b32 s66, v2
    s_bfe_u32 s75, s2, 0x20003
    s_bfe_u32 s68, s2, 0x20001
    s_lshl2_add_u32 s68, s68, s75
    s_and_b32 s67, s66, 3
    s_lshl1_add_u32 s93, s75, s70
    s_cmp_ge_u32 s93, 7
    s_cselect_b32 s76, 7, 0
    s_sub_u32 s93, s93, s76
    v_lshrrev_b32 v2, 3, v1
    v_and_b32 v5, 7, v1
    v_lshrrev_b32 v6, 1, v2
    v_xor_b32 v5, v5, v6
    v_mul_u32_u24 v2, 896, v2
    v_lshl_add_u32 v4, v5, 4, v2
    v_xor_b32 v5, 64, v4
    v_add_u32 v6, 12288, v4
    v_add_u32 v5, 6144, v5
    v_add_u32 v7, 12288, v5
    s_lshl2_add_u32 s74, s68, s67
    s_mul_i32 s90, s74, 28672
    s_mul_i32 s91, s67, 28672
    s_lshl_b32 s76, s93, 7
    s_mov_b32 s30, 1835008
    s_mov_b32 s31, 0x20000
    s_getpc_b64 s[64:65]
L_pc:
    s_and_b32 s77, s2, 0xf8
    s_add_u32 s77, s77, s66
    s_mul_i32 s77, s77, 192
    s_min_u32 s77, s77, L_codeend-L_pc-192
    s_add_u32 s64, s64, s77
    s_addc_u32 s65, s65, 0
    s_cmp_lt_u32 s66, 4
    s_waitcnt lgkmcnt(0)
    s_mov_b32 s28, s4
    s_mov_b32 s29, s5
    s_cbranch_scc1 L_A
    s_add_u32 m0, s91, 0
    s_add_u32 s75, s90, s76
    buffer_load_dwordx4 v4, s[28:31], s75 offen offset:0 lds
    buffer_load_dwordx4 v5, s[28:31], s75 offen offset:1024 lds
    buffer_load_dwordx4 v6, s[28:31], s75 offen offset:2048 lds
    buffer_load_dwordx4 v7, s[28:31], s75 offen offset:3072 lds
    s_add_u32 s76, s76, 128
    s_cmp_eq_u32 s76, 896
    s_cselect_b32 s76, 0, s76
    s_add_u32 m0, s91, 4096
    s_add_u32 s75, s90, s76
    buffer_load_dwordx4 v4, s[28:31], s75 offen offset:0 lds
    buffer_load_dwordx4 v5, s[28:31], s75 offen offset:1024 lds
    buffer_load_dwordx4 v6, s[28:31], s75 offen offset:2048 lds
    buffer_load_dwordx4 v7, s[28:31], s75 offen offset:3072 lds
    s_add_u32 s76, s76, 128
    s_cmp_eq_u32 s76, 896
    s_cselect_b32 s76, 0, s76
    s_add_u32 m0, s91, 8192
    s_add_u32 s75, s90, s76
    buffer_load_dwordx4 v4, s[28:31], s75 offen offset:0 lds
    buffer_load_dwordx4 v5, s[28:31], s75 offen offset:1024 lds
    buffer_load_dwordx4 v6, s[28:31], s75 offen offset:2048 lds
    buffer_load_dwordx4 v7, s[28:31], s75 offen offset:3072 lds
    s_add_u32 s76, s76, 128
    s_cmp_eq_u32 s76, 896
    s_cselect_b32 s76, 0, s76
    s_load_dword s96, s[64:65], 0
    s_load_dword s97, s[64:65], 64
    s_load_dword s98, s[64:65], 128
    s_branch L_G
L_A:
    s_and_b32 s71, s2, 1
    s_lshl3_add_u32 s69, s71, s70
    s_sub_u32 s72, s69, s71
    s_mov_b32 s86, 0xffff0000
    s_mov_b32 s94, 0
    s_mov_b32 s95, -1
    s_lshr_b32 s82, s70, 1
    s_lshl2_add_u32 s82, s71, s82
    s_and_b32 s81, s70, 1
    s_cmp_eq_u32 s70, 6
    s_cselect_b32 s82, 3, s82
    s_cselect_b32 s81, s71, s81
    s_bitcmp1_b32 s66, 0
    s_cselect_b32 s32, s18, s16
    s_cselect_b32 s33, s19, s17
    s_mov_b32 s34, 1605632
    s_mov_b32 s35, 0x20000
    s_mov_b32 s36, s6
    s_mov_b32 s37, s7
    s_mov_b32 s38, 401408
    s_mov_b32 s39, 0x20000
    s_mov_b32 s40, s26
    s_mov_b32 s41, s27
    s_mov_b32 s42, 10223616
    s_mov_b32 s43, 0x20000
    s_mov_b32 s52, s22
    s_mov_b32 s53, s23
    s_mov_b32 s54, 1835008
    s_mov_b32 s55, 0x20000
    s_mov_b32 s56, s24
    s_mov_b32 s57, s25
    s_mov_b32 s58, 256
    s_mov_b32 s59, 0x20000
    s_mov_b32 s44, s20
    s_mov_b32 s45, s21
    s_mov_b32 s46, 1605632
    s_mov_b32 s47, 0x20000
    s_mov_b32 s48, s12
    s_mov_b32 s49, s13
    s_mov_b32 s50, 401408
    s_mov_b32 s51, 0x20000
    v_lshrrev_b32 v4, 3, v1
    s_lshr_b32 s74, s66, 1
    s_and_b32 s75, s66, 1
    s_lshl_b32 s91, s66, 10
    v_and_b32 v5, 2, v4
    s_lshl_b32 s75, s75, 2
    v_or_b32 v5, s75, v5
    v_and_b32 v6, 7, v1
    v_xor_b32 v5, v5, v6
    s_mul_i32 s74, s74, 28672
    s_lshl_b32 s75, s72, 8
    s_add_u32 s74, s74, s75
    v_mul_u32_u24 v4, 3584, v4
    v_lshl_add_u32 v2, v5, 4, v4
    v_add_u32 v2, s74, v2
    v_lshrrev_b32 v4, 2, v1
    v_and_b32 v5, 3, v1
    v_lshlrev_b32 v5, 4, v5
    v_mad_u32_u24 v7, v4, 56, v5
    v_mul_u32_u24 v4, 896, v4
    s_mul_i32 s74, s69, 56
    v_add3_u32 v3, v4, v5, s74
    s_lshl_b32 s76, s66, 10
    s_mul_i32 s77, s66, 14336
    s_cmp_eq_u32 s70, 7
    s_cbranch_scc1 L_A_light
    s_mul_i32 s4, s93, 229376
    s_add_u32 s5, s4, 229376
    s_cmp_eq_u32 s5, 1605632
    s_cselect_b32 s5, 0, s5
    s_add_u32 s6, s5, 229376
    s_cmp_eq_u32 s6, 1605632
    s_cselect_b32 s6, 0, s6
    s_add_u32 s7, s6, 229376
    s_cmp_eq_u32 s7, 1605632
    s_cselect_b32 s7, 0, s7
    s_add_u32 s8, s7, 229376
    s_cmp_eq_u32 s8, 1605632
    s_cselect_b32 s8, 0, s8
    s_add_u32 s9, s8, 229376
    s_cmp_eq_u32 s9, 1605632
    s_cselect_b32 s9, 0, s9
    s_add_u32 s10, s9, 229376
    s_cmp_eq_u32 s10, 1605632
    s_cselect_b32 s10, 0, s10
    s_load_dword s96, s[64:65], 0
    s_load_dword s97, s[64:65], 64
    s_load_dword s98, s[64:65], 128
    s_mul_i32 s11, s93, 57344
    s_add_u32 s12, s11, 57344
    s_cmp_eq_u32 s12, 401408
    s_cselect_b32 s12, 0, s12
    s_add_u32 s13, s12, 57344
    s_cmp_eq_u32 s13, 401408
    s_cselect_b32 s13, 0, s13
    s_add_u32 s14, s13, 57344
    s_cmp_eq_u32 s14, 401408
    s_cselect_b32 s14, 0, s14
    s_add_u32 s15, s14, 57344
    s_cmp_eq_u32 s15, 401408
    s_cselect_b32 s15, 0, s15
    s_add_u32 s16, s15, 57344
    s_cmp_eq_u32 s16, 401408
    s_cselect_b32 s16, 0, s16
    s_add_u32 s17, s16, 57344
    s_cmp_eq_u32 s17, 401408
    s_cselect_b32 s17, 0, s17
    s_add_u32 s11, s11, s77
    s_add_u32 s12, s12, s77
    s_add_u32 s13, s13, s77
    s_add_u32 s14, s14, s77
    s_add_u32 s15, s15, s77
    s_add_u32 s16, s16, s77
    s_add_u32 s17, s17, s77
    v_mov_b32 v64, 0
    v_mov_b32 v65, 0
    v_mov_b32 v66, 0
    v_mov_b32 v67, 0
    v_mov_b32 v68, 0
    v_mov_b32 v69, 0
    v_mov_b32 v70, 0
    v_mov_b32 v71, 0
    v_mov_b32 v72, 0
    v_mov_b32 v73, 0
    v_mov_b32 v74, 0
    v_mov_b32 v75, 0
    v_mov_b32 v76, 0
    v_mov_b32 v77, 0
    v_mov_b32 v78, 0
    v_mov_b32 v79, 0
    v_mov_b32 v80, 0
    v_mov_b32 v81, 0
    v_mov_b32 v82, 0
    v_mov_b32 v83, 0
    v_mov_b32 v84, 0
    v_mov_b32 v85, 0
    v_mov_b32 v86, 0
    v_mov_b32 v87, 0
    v_mov_b32 v88, 0
    v_mov_b32 v89, 0
    v_mov_b32 v90, 0
    v_mov_b32 v91, 0
    v_mov_b32 v92, 0
    v_mov_b32 v93, 0
    v_mov_b32 v94, 0
    v_mov_b32 v95, 0
    v_mov_b32 v96, 0
    v_mov_b32 v97, 0
    v_mov_b32 v98, 0
    v_mov_b32 v99, 0
    v_mov_b32 v100, 0
    v_mov_b32 v101, 0
    v_mov_b32 v102, 0
    v_mov_b32 v103, 0
    v_mov_b32 v104, 0
    v_mov_b32 v105, 0
    v_mov_b32 v106, 0
    v_mov_b32 v107, 0
    v_mov_b32 v108, 0
    v_mov_b32 v109, 0
    v_mov_b32 v110, 0
    v_mov_b32 v111, 0
    v_mov_b32 v112, 0
    v_mov_b32 v113, 0
    v_mov_b32 v114, 0
    v_mov_b32 v115, 0
    v_mov_b32 v116, 0
    v_mov_b32 v117, 0
    v_mov_b32 v118, 0
    v_mov_b32 v119, 0
    v_mov_b32 v120, 0
    v_mov_b32 v121, 0
    v_mov_b32 v122, 0
    v_mov_b32 v123, 0
    v_mov_b32 v124, 0
    v_mov_b32 v125, 0
    v_mov_b32 v126, 0
    v_mov_b32 v127, 0
    v_mov_b32 v48, 0
    v_mov_b32 v49, 0
    v_mov_b32 v50, 0
    v_mov_b32 v51, 0
    v_mov_b32 v52, 0
    v_mov_b32 v53, 0
    v_mov_b32 v54, 0
    v_mov_b32 v55, 0
    v_mov_b32 v46, 0
    v_mov_b32 v47, 0
    v_mov_b32 v216, 0
    v_mov_b32 v217, 0
    v_mov_b32 v218, 0
    v_mov_b32 v219, 0
    v_mov_b32 v220, 0
    v_mov_b32 v221, 0
    v_mov_b32 v222, 0
    v_mov_b32 v223, 0
    v_lshlrev_b32 v8, 4, v1
    v_mov_b32 v56, 0
    s_lshr_b32 s74, s2, 1
    s_and_b32 s74, s74, 0x7c
    s_add_u32 s74, s74, s66
    s_mul_i32 s18, s74, 12544
    v_lshlrev_b32 v9, 7, v1
    s_mul_i32 s19, s74, 7
    s_lshr_b32 s19, s19, 1
    s_mul_i32 s19, s19, 896
    v_lshrrev_b32 v14, 2, v1
    v_mul_u32_u24 v14, 896, v14
    v_and_b32 v15, 3, v1
    v_lshl_add_u32 v14, v15, 7, v14
    s_mul_i32 s74, s71, 384
    v_add_u32 v14, s74, v14
    s_barrier
    s_add_u32 m0, s91, 114688
    s_add_u32 s90, s4, 0
    buffer_load_dwordx4 v2, s[32:35], s90 offen lds
    s_add_u32 m0, s91, 118784
    s_add_u32 s90, s4, 57344
    buffer_load_dwordx4 v2, s[32:35], s90 offen lds
    s_add_u32 m0, s91, 122880
    s_add_u32 s90, s4, 114688
    buffer_load_dwordx4 v2, s[32:35], s90 offen lds
    s_add_u32 m0, s91, 126976
    s_add_u32 s90, s4, 172032
    buffer_load_dwordx4 v2, s[32:35], s90 offen lds
    s_add_u32 m0, s91, 131072
    s_add_u32 s90, s5, 0
    buffer_load_dwordx4 v2, s[32:35], s90 offen lds
    s_add_u32 m0, s91, 135168
    s_add_u32 s90, s5, 57344
    buffer_load_dwordx4 v2, s[32:35], s90 offen lds
    s_add_u32 m0, s91, 139264
    s_add_u32 s90, s5, 114688
    buffer_load_dwordx4 v2, s[32:35], s90 offen lds
    s_add_u32 m0, s91, 143360
    s_add_u32 s90, s5, 172032
    buffer_load_dwordx4 v2, s[32:35], s90 offen lds
    s_add_u32 m0, s91, 147456
    s_add_u32 s90, s6, 0
    buffer_load_dwordx4 v2, s[32:35], s90 offen lds
    s_add_u32 m0, s91, 151552
    s_add_u32 s90, s6, 57344
    buffer_load_dwordx4 v2, s[32:35], s90 offen lds
    s_add_u32 m0, s91, 155648
    s_add_u32 s90, s6, 114688
    buffer_load_dwordx4 v2, s[32:35], s90 offen lds
    s_add_u32 m0, s91, 159744
    s_add_u32 s90, s6, 172032
    buffer_load_dwordx4 v2, s[32:35], s90 offen lds
    s_barrier
    s_waitcnt vmcnt(8)
    s_barrier
    s_add_u32 m0, s91, 0
    s_add_u32 s90, s7, 0
    buffer_load_dwordx4 v2, s[32:35], s90 offen lds
    s_add_u32 m0, s91, 4096
    s_add_u32 s90, s7, 57344
    buffer_load_dwordx4 v2, s[32:35], s90 offen lds
    s_add_u32 m0, s91, 8192
    s_add_u32 s90, s7, 114688
    buffer_load_dwordx4 v2, s[32:35], s90 offen lds
    s_add_u32 m0, s91, 12288
    s_add_u32 s90, s7, 172032
    buffer_load_dwordx4 v2, s[32:35], s90 offen lds
    s_add_u32 m0, s91, 16384
    s_add_u32 s90, s8, 0
    buffer_load_dwordx4 v2, s[32:35], s90 offen lds
    s_add_u32 m0, s91, 20480
    s_add_u32 s90, s8, 57344
    buffer_load_dwordx4 v2, s[32:35], s90 offen lds
    s_add_u32 m0, s91, 24576
    s_add_u32 s90, s8, 114688
    buffer_load_dwordx4 v2, s[32:35], s90 offen lds
    s_add_u32 m0, s91, 28672
    s_add_u32 s90, s8, 172032
    buffer_load_dwordx4 v2, s[32:35], s90 offen lds
    s_add_u32 m0, s91, 32768
    s_add_u32 s90, s9, 0
    buffer_load_dwordx4 v2, s[32:35], s90 offen lds
    s_add_u32 m0, s91, 36864
    s_add_u32 s90, s9, 57344
    buffer_load_dwordx4 v2, s[32:35], s90 offen lds
    s_add_u32 m0, s91, 40960
    s_add_u32 s90, s9, 114688
    buffer_load_dwordx4 v2, s[32:35], s90 offen lds
    s_add_u32 m0, s91, 45056
    s_add_u32 s90, s9, 172032
    buffer_load_dwordx4 v2, s[32:35], s90 offen lds
    s_waitcnt vmcnt(12)
    s_barrier
    s_add_u32 m0, s91, 49152
    s_add_u32 s90, s10, 0
    buffer_load_dwordx4 v2, s[32:35], s90 offen lds
    s_add_u32 m0, s91, 53248
    s_add_u32 s90, s10, 57344
    buffer_load_dwordx4 v2, s[32:35], s90 offen lds
    s_add_u32 m0, s91, 57344
    s_add_u32 s90, s10, 114688
    buffer_load_dwordx4 v2, s[32:35], s90 offen lds
    s_add_u32 m0, s91, 61440
    s_add_u32 s90, s10, 172032
    buffer_load_dwordx4 v2, s[32:35], s90 offen lds
    s_add_u32 m0, s91, 65536
    s_add_u32 s90, s4, 128
    buffer_load_dwordx4 v2, s[32:35], s90 offen lds
    s_add_u32 m0, s91, 69632
    s_add_u32 s90, s4, 57472
    buffer_load_dwordx4 v2, s[32:35], s90 offen lds
    s_add_u32 m0, s91, 73728
    s_add_u32 s90, s4, 114816
    buffer_load_dwordx4 v2, s[32:35], s90 offen lds
    s_add_u32 m0, s91, 77824
    s_add_u32 s90, s4, 172160
    buffer_load_dwordx4 v2, s[32:35], s90 offen lds
    s_add_u32 m0, s91, 81920
    s_add_u32 s90, s5, 128
    buffer_load_dwordx4 v2, s[32:35], s90 offen lds
    s_add_u32 m0, s91, 86016
    s_add_u32 s90, s5, 57472
    buffer_load_dwordx4 v2, s[32:35], s90 offen lds
    s_add_u32 m0, s91, 90112
    s_add_u32 s90, s5, 114816
    buffer_load_dwordx4 v2, s[32:35], s90 offen lds
    s_add_u32 m0, s91, 94208
    s_add_u32 s90, s5, 172160
    buffer_load_dwordx4 v2, s[32:35], s90 offen lds
    s_waitcnt vmcnt(16)
    s_barrier
    s_add_u32 m0, s91, 98304
    s_add_u32 s90, s6, 128
    buffer_load_dwordx4 v2, s[32:35], s90 offen lds
    s_add_u32 m0, s91, 102400
    s_add_u32 s90, s6, 57472
    buffer_load_dwordx4 v2, s[32:35], s90 offen lds
    s_add_u32 m0, s91, 106496
    s_add_u32 s90, s6, 114816
    buffer_load_dwordx4 v2, s[32:35], s90 offen lds
    s_add_u32 m0, s91, 110592
    s_add_u32 s90, s6, 172160
    buffer_load_dwordx4 v2, s[32:35], s90 offen lds
    s_add_u32 m0, s91, 114688
    s_add_u32 s90, s7, 128
    buffer_load_dwordx4 v2, s[32:35], s90 offen lds
    s_add_u32 m0, s91, 118784
    s_add_u32 s90, s7, 57472
    buffer_load_dwordx4 v2, s[32:35], s90 offen lds
    s_add_u32 m0, s91, 122880
    s_add_u32 s90, s7, 114816
    buffer_load_dwordx4 v2, s[32:35], s90 offen lds
    s_add_u32 m0, s91, 126976
    s_add_u32 s90, s7, 172160
    buffer_load_dwordx4 v2, s[32:35], s90 offen lds
    s_add_u32 m0, s91, 131072
    s_add_u32 s90, s8, 128
    buffer_load_dwordx4 v2, s[32:35], s90 offen lds
    s_add_u32 m0, s91, 135168
    s_add_u32 s90, s8, 57472
    buffer_load_dwordx4 v2, s[32:35], s90 offen lds
    s_add_u32 m0, s91, 139264
    s_add_u32 s90, s8, 114816
    buffer_load_dwordx4 v2, s[32:35], s90 offen lds
    s_add_u32 m0, s91, 143360
    s_add_u32 s90, s8, 172160
    buffer_load_dwordx4 v2, s[32:35], s90 offen lds
    s_add_u32 m0, s91, 147456
    s_add_u32 s90, s9, 128
    buffer_load_dwordx4 v2, s[32:35], s90 offen lds
    s_add_u32 m0, s91, 151552
    s_add_u32 s90, s9, 57472
    buffer_load_dwordx4 v2, s[32:35], s90 offen lds
    s_waitcnt vmcnt(22)
    s_barrier
    s_add_u32 m0, s91, 155648
    s_add_u32 s90, s9, 114816
    buffer_load_dwordx4 v2, s[32:35], s90 offen lds
    s_add_u32 m0, s91, 159744
    s_add_u32 s90, s9, 172160
    buffer_load_dwordx4 v2, s[32:35], s90 offen lds
    s_add_u32 m0, s91, 0
    s_add_u32 s90, s10, 128
    buffer_load_dwordx4 v2, s[32:35], s90 offen lds
    s_add_u32 m0, s91, 4096
    s_add_u32 s90, s10, 57472
    buffer_load_dwordx4 v2, s[32:35], s90 offen lds
    s_add_u32 m0, s91, 8192
    s_add_u32 s90, s10, 114816
    buffer_load_dwordx4 v2, s[32:35], s90 offen lds
    s_add_u32 m0, s91, 12288
    s_add_u32 s90, s10, 172160
    buffer_load_dwordx4 v2, s[32:35], s90 offen lds
    s_add_u32 m0, s76, 16384
    s_nop 0
    buffer_load_dwordx4 v3, s[36:39], s11 offen lds
    s_add_u32 m0, s76, 20480
    s_nop 0
    buffer_load_dwordx4 v3, s[36:39], s12 offen lds
    s_add_u32 m0, s76, 24576
    s_nop 0
    buffer_load_dwordx4 v3, s[36:39], s13 offen lds
    s_mov_b32 exec_lo, 0xffffffff
    s_mov_b32 exec_hi, 0x0
    s_add_u32 s75, s18, 0
    buffer_load_dword v228, v14, s[44:47], s75 offen
    s_mov_b64 exec, -1
    s_waitcnt vmcnt(20)
    s_barrier
    s_add_u32 m0, s76, 28672
    s_nop 0
    buffer_load_dwordx4 v3, s[36:39], s14 offen lds
    s_add_u32 m0, s76, 32768
    s_nop 0
    buffer_load_dwordx4 v3, s[36:39], s15 offen lds
    s_add_u32 m0, s76, 36864
    s_nop 0
    buffer_load_dwordx4 v3, s[36:39], s16 offen lds
    s_add_u32 m0, s76, 40960
    s_nop 0
    buffer_load_dwordx4 v3, s[36:39], s17 offen lds
    s_mov_b32 exec_lo, 0xffffff
    s_mov_b32 exec_hi, 0x0
    s_add_u32 s75, s18, 7168
    buffer_load_dword v232, v14, s[44:47], s75 offen
    s_mov_b64 exec, -1
    s_waitcnt vmcnt(13)
    s_barrier
    s_mov_b64 exec, 0xffff
    buffer_load_dword v235, v14, s[48:51], s19 offen
    s_mov_b64 exec, -1
    s_waitcnt vmcnt(2)
    s_barrier
    s_lshl_b32 s74, s68, 2
    s_add_u32 s74, s74, s67
    s_lshl_b32 s83, s74, 4
    s_add_u32 s83, s83, s69
    s_lshl_b32 s83, s83, 11
    s_add_u32 s83, s83, 524288
    v_mov_b32 v240, -1
    v_mov_b32 v241, -1
    v_mov_b32 v242, -1
    v_mov_b32 v243, -1
    buffer_store_dwordx4 v[240:243], v8, s[40:43], s83 offen offset:0 sc1
    buffer_store_dwordx4 v[240:243], v8, s[40:43], s83 offen offset:1024 sc1
L_A_join:
    v_mov_b32 v4, 128
    s_mov_b32 s78, 4194304
L_pkv:
    buffer_load_dword v5, v4, s[56:59], 0 offen sc1
    s_waitcnt vmcnt(0)
    v_cmp_eq_u32 vcc, 0, v5
    s_nop 0
    s_cmp_lg_u64 vcc, 0
    s_cbranch_scc0 L_pkv_ok
    s_sub_u32 s78, s78, 1
    s_cselect_b32 s78, 0, s78
    s_cbranch_scc1 L_pkv_ok
    s_sleep 4
    s_branch L_pkv
L_pkv_ok:
    v_lshlrev_b32 v4, 2, v1
    s_mov_b32 s74, 262144
    buffer_load_dword v5, v4, s[40:43], s74 offen sc1
    s_lshl_b32 s90, s66, 16
    buffer_load_dwordx4 v[160:163], v8, s[40:43], s90 offen offset:0 sc1
    buffer_load_dwordx4 v[164:167], v8, s[40:43], s90 offen offset:1024 sc1
    buffer_load_dwordx4 v[192:195], v8, s[40:43], s90 offen offset:2048 sc1
    buffer_load_dwordx4 v[196:199], v8, s[40:43], s90 offen offset:3072 sc1
    s_add_u32 s90, s90, 4096
    buffer_load_dwordx4 v[168:171], v8, s[40:43], s90 offen offset:0 sc1
    buffer_load_dwordx4 v[172:175], v8, s[40:43], s90 offen offset:1024 sc1
    buffer_load_dwordx4 v[200:203], v8, s[40:43], s90 offen offset:2048 sc1
    buffer_load_dwordx4 v[204:207], v8, s[40:43], s90 offen offset:3072 sc1
    s_add_u32 s90, s90, 4096
    buffer_load_dwordx4 v[176:179], v8, s[40:43], s90 offen offset:0 sc1
    buffer_load_dwordx4 v[180:183], v8, s[40:43], s90 offen offset:1024 sc1
    buffer_load_dwordx4 v[208:211], v8, s[40:43], s90 offen offset:2048 sc1
    buffer_load_dwordx4 v[212:215], v8, s[40:43], s90 offen offset:3072 sc1
    s_add_u32 s90, s90, 4096
    s_add_u32 s74, s66, 1
    s_and_b32 s74, s74, 3
    s_lshl_b32 s74, s74, 11
    s_add_u32 s74, s74, 49152
    v_add_u32 v10, s74, v8
    s_add_u32 s74, s66, 2
    s_and_b32 s74, s74, 3
    s_lshl_b32 s74, s74, 11
    s_add_u32 s74, s74, 49152
    v_add_u32 v11, s74, v8
    s_add_u32 s74, s66, 3
    s_and_b32 s74, s74, 3
    s_lshl_b32 s74, s74, 11
    s_add_u32 s74, s74, 49152
    v_add_u32 v12, s74, v8
    s_add_u32 s74, s66, 4
    s_and_b32 s74, s74, 3
    s_lshl_b32 s74, s74, 11
    s_add_u32 s74, s74, 49152
    v_add_u32 v13, s74, v8
    s_add_u32 s74, s66, 1
    s_and_b32 s74, s74, 3
    s_mul_i32 s74, s74, 12288
    v_add_u32 v224, s74, v8
    s_add_u32 s74, s66, 2
    s_and_b32 s74, s74, 3
    s_mul_i32 s74, s74, 12288
    v_add_u32 v225, s74, v8
    s_add_u32 s74, s66, 3
    s_and_b32 s74, s74, 3
    s_mul_i32 s74, s74, 12288
    v_add_u32 v226, s74, v8
    s_add_u32 s74, s66, 4
    s_and_b32 s74, s74, 3
    s_mul_i32 s74, s74, 12288
    v_add_u32 v227, s74, v8
    v_lshrrev_b32 v6, 5, v1
    v_and_b32 v7, 31, v1
    v_lshlrev_b32 v7, 2, v7
    v_lshl_add_u32 v6, v6, 8, v7
    s_waitcnt vmcnt(12) lgkmcnt(0)
    s_nop 1
    v_max_f32_dpp v5, v5, v5 row_shr:1 row_mask:0xf bank_mask:0xf
    s_nop 1
    v_max_f32_dpp v5, v5, v5 row_shr:2 row_mask:0xf bank_mask:0xf
    s_nop 1
    v_max_f32_dpp v5, v5, v5 row_shr:4 row_mask:0xf bank_mask:0xf
    s_nop 1
    v_max_f32_dpp v5, v5, v5 row_shr:8 row_mask:0xf bank_mask:0xf
    s_nop 1
    v_max_f32_dpp v5, v5, v5 row_bcast:15 row_mask:0xa bank_mask:0xf
    s_nop 1
    v_max_f32_dpp v5, v5, v5 row_bcast:31 row_mask:0xc bank_mask:0xf
    s_nop 1
    v_readlane_b32 s79, v5, 63
    s_barrier
    ds_read_b128 v[128:131], v10
    ds_read_b128 v[132:135], v10 offset:1024
    ds_read_b128 v[136:139], v11
    ds_read_b128 v[140:143], v11 offset:1024
    ds_read_b128 v[144:147], v12
    ds_read_b128 v[148:151], v12 offset:1024
    ds_read_b128 v[152:155], v13
    ds_read_b128 v[156:159], v13 offset:1024
    s_waitcnt vmcnt(8) lgkmcnt(6)
    v_mfma_f32_32x32x16_bf16 v[16:31], v[160:163], v[128:131], 0
    v_mfma_f32_32x32x16_bf16 v[16:31], v[164:167], v[132:135], v[16:31]
    s_barrier
    ds_read_b32 v4, v6 offset:57344
    ds_read_b32 v5, v6 offset:57856
    s_mov_b32 s78, 3
    v_mov_b32 v10, 58368
    v_mov_b32 v11, 1
    s_waitcnt lgkmcnt(0)
    v_max_f32 v4, v4, v5
    v_mul_f32 v4, s79, v4
    v_cmp_nge_f32 vcc, 0x45c41414, v4
    s_nop 1
    s_cbranch_vccnz L_fallback
    .p2align 6
L_attn_loop:
    v_cvt_pk_bf16_f32 v55, v46, v47
    v_mfma_f32_32x32x16_bf16 v[32:47], v[160:163], v[136:139], 0
    v_exp_f32 v16, v16
    v_exp_f32 v17, v17
    v_exp_f32 v18, v18
    v_mfma_f32_32x32x16_bf16 v[32:47], v[164:167], v[140:143], v[32:47]
    v_exp_f32 v19, v19
    v_exp_f32 v20, v20
    v_exp_f32 v21, v21
    v_mfma_f32_32x32x16_bf16 v[112:127], v[216:219], v[48:51], v[112:127]
    v_exp_f32 v22, v22
    v_exp_f32 v23, v23
    v_exp_f32 v24, v24
    v_mfma_f32_32x32x16_bf16 v[112:127], v[220:223], v[52:55], v[112:127]
    buffer_load_dwordx4 v[184:187], v8, s[40:43], s90 offen offset:0 sc1
    buffer_load_dwordx4 v[188:191], v8, s[40:43], s90 offen offset:1024 sc1
    buffer_load_dwordx4 v[216:219], v8, s[40:43], s90 offen offset:2048 sc1
    buffer_load_dwordx4 v[220:223], v8, s[40:43], s90 offen offset:3072 sc1
    v_exp_f32 v25, v25
    v_cvt_pk_bf16_f32 v48, v16, v17
    v_exp_f32 v26, v26
    v_cvt_pk_bf16_f32 v49, v18, v19
    v_exp_f32 v27, v27
    v_cvt_pk_bf16_f32 v50, v20, v21
    v_exp_f32 v28, v28
    v_cvt_pk_bf16_f32 v51, v22, v23
    v_exp_f32 v29, v29
    v_cvt_pk_bf16_f32 v52, v24, v25
    v_exp_f32 v30, v30
    v_cvt_pk_bf16_f32 v53, v26, v27
    v_exp_f32 v31, v31
    v_cvt_pk_bf16_f32 v54, v28, v29
    v_cvt_pk_bf16_f32 v55, v30, v31
    v_mfma_f32_32x32x16_bf16 v[16:31], v[160:163], v[144:147], 0
    s_add_u32 s90, s90, 4096
    v_exp_f32 v32, v32
    v_exp_f32 v33, v33
    v_exp_f32 v34, v34
    v_mfma_f32_32x32x16_bf16 v[16:31], v[164:167], v[148:151], v[16:31]
    v_exp_f32 v35, v35
    v_exp_f32 v36, v36
    v_exp_f32 v37, v37
    v_mfma_f32_32x32x16_bf16 v[64:79], v[192:195], v[48:51], v[64:79]
    v_exp_f32 v38, v38
    v_exp_f32 v39, v39
    v_exp_f32 v40, v40
    v_mfma_f32_32x32x16_bf16 v[64:79], v[196:199], v[52:55], v[64:79]
    v_exp_f32 v41, v41
    v_cvt_pk_bf16_f32 v48, v32, v33
    v_exp_f32 v42, v42
    v_cvt_pk_bf16_f32 v49, v34, v35
    v_exp_f32 v43, v43
    v_cvt_pk_bf16_f32 v50, v36, v37
    v_exp_f32 v44, v44
    v_cvt_pk_bf16_f32 v51, v38, v39
    v_exp_f32 v45, v45
    v_cvt_pk_bf16_f32 v52, v40, v41
    v_exp_f32 v46, v46
    v_cvt_pk_bf16_f32 v53, v42, v43
    v_exp_f32 v47, v47
    v_cvt_pk_bf16_f32 v54, v44, v45
    v_cvt_pk_bf16_f32 v55, v46, v47
    v_mfma_f32_32x32x16_bf16 v[32:47], v[160:163], v[152:155], 0
    v_exp_f32 v16, v16
    v_exp_f32 v17, v17
    v_exp_f32 v18, v18
    v_mfma_f32_32x32x16_bf16 v[32:47], v[164:167], v[156:159], v[32:47]
    v_exp_f32 v19, v19
    v_exp_f32 v20, v20
    v_exp_f32 v21, v21
    v_mfma_f32_32x32x16_bf16 v[80:95], v[192:195], v[48:51], v[80:95]
    v_exp_f32 v22, v22
    v_exp_f32 v23, v23
    v_exp_f32 v24, v24
    v_mfma_f32_32x32x16_bf16 v[80:95], v[196:199], v[52:55], v[80:95]
    s_waitcnt vmcnt(8)
    v_exp_f32 v25, v25
    v_cvt_pk_bf16_f32 v48, v16, v17
    v_exp_f32 v26, v26
    v_cvt_pk_bf16_f32 v49, v18, v19
    v_exp_f32 v27, v27
    v_cvt_pk_bf16_f32 v50, v20, v21
    v_exp_f32 v28, v28
    v_cvt_pk_bf16_f32 v51, v22, v23
    v_exp_f32 v29, v29
    v_cvt_pk_bf16_f32 v52, v24, v25
    v_exp_f32 v30, v30
    v_cvt_pk_bf16_f32 v53, v26, v27
    v_exp_f32 v31, v31
    v_cvt_pk_bf16_f32 v54, v28, v29
    v_cvt_pk_bf16_f32 v55, v30, v31
    v_mfma_f32_32x32x16_bf16 v[16:31], v[168:171], v[128:131], 0
    v_exp_f32 v32, v32
    v_exp_f32 v33, v33
    v_exp_f32 v34, v34
    v_mfma_f32_32x32x16_bf16 v[16:31], v[172:175], v[132:135], v[16:31]
    v_exp_f32 v35, v35
    v_exp_f32 v36, v36
    v_exp_f32 v37, v37
    v_mfma_f32_32x32x16_bf16 v[96:111], v[192:195], v[48:51], v[96:111]
    v_exp_f32 v38, v38
    v_exp_f32 v39, v39
    v_exp_f32 v40, v40
    v_mfma_f32_32x32x16_bf16 v[96:111], v[196:199], v[52:55], v[96:111]
    v_exp_f32 v41, v41
    v_cvt_pk_bf16_f32 v48, v32, v33
    v_exp_f32 v42, v42
    v_cvt_pk_bf16_f32 v49, v34, v35
    v_exp_f32 v43, v43
    v_cvt_pk_bf16_f32 v50, v36, v37
    v_exp_f32 v44, v44
    v_cvt_pk_bf16_f32 v51, v38, v39
    v_exp_f32 v45, v45
    v_cvt_pk_bf16_f32 v52, v40, v41
    v_exp_f32 v46, v46
    v_cvt_pk_bf16_f32 v53, v42, v43
    v_exp_f32 v47, v47
    v_cvt_pk_bf16_f32 v54, v44, v45
    v_cvt_pk_bf16_f32 v55, v46, v47
    v_mfma_f32_32x32x16_bf16 v[32:47], v[168:171], v[136:139], 0
    v_exp_f32 v16, v16
    v_exp_f32 v17, v17
    v_exp_f32 v18, v18
    v_mfma_f32_32x32x16_bf16 v[32:47], v[172:175], v[140:143], v[32:47]
    v_exp_f32 v19, v19
    v_exp_f32 v20, v20
    v_exp_f32 v21, v21
    v_mfma_f32_32x32x16_bf16 v[112:127], v[192:195], v[48:51], v[112:127]
    v_exp_f32 v22, v22
    v_exp_f32 v23, v23
    v_exp_f32 v24, v24
    v_mfma_f32_32x32x16_bf16 v[112:127], v[196:199], v[52:55], v[112:127]
    buffer_load_dwordx4 v[160:163], v8, s[40:43], s90 offen offset:0 sc1
    buffer_load_dwordx4 v[164:167], v8, s[40:43], s90 offen offset:1024 sc1
    buffer_load_dwordx4 v[192:195], v8, s[40:43], s90 offen offset:2048 sc1
    buffer_load_dwordx4 v[196:199], v8, s[40:43], s90 offen offset:3072 sc1
    v_exp_f32 v25, v25
    v_cvt_pk_bf16_f32 v48, v16, v17
    v_exp_f32 v26, v26
    v_cvt_pk_bf16_f32 v49, v18, v19
    v_exp_f32 v27, v27
    v_cvt_pk_bf16_f32 v50, v20, v21
    v_exp_f32 v28, v28
    v_cvt_pk_bf16_f32 v51, v22, v23
    v_exp_f32 v29, v29
    v_cvt_pk_bf16_f32 v52, v24, v25
    v_exp_f32 v30, v30
    v_cvt_pk_bf16_f32 v53, v26, v27
    v_exp_f32 v31, v31
    v_cvt_pk_bf16_f32 v54, v28, v29
    v_cvt_pk_bf16_f32 v55, v30, v31
    v_mfma_f32_32x32x16_bf16 v[16:31], v[168:171], v[144:147], 0
    s_add_u32 s90, s90, 4096
    v_exp_f32 v32, v32
    v_exp_f32 v33, v33
    v_exp_f32 v34, v34
    v_mfma_f32_32x32x16_bf16 v[16:31], v[172:175], v[148:151], v[16:31]
    v_exp_f32 v35, v35
    v_exp_f32 v36, v36
    v_exp_f32 v37, v37
    v_mfma_f32_32x32x16_bf16 v[64:79], v[200:203], v[48:51], v[64:79]
    v_exp_f32 v38, v38
    v_exp_f32 v39, v39
    v_exp_f32 v40, v40
    v_mfma_f32_32x32x16_bf16 v[64:79], v[204:207], v[52:55], v[64:79]
    v_exp_f32 v41, v41
    v_cvt_pk_bf16_f32 v48, v32, v33
    v_exp_f32 v42, v42
    v_cvt_pk_bf16_f32 v49, v34, v35
    v_exp_f32 v43, v43
    v_cvt_pk_bf16_f32 v50, v36, v37
    v_exp_f32 v44, v44
    v_cvt_pk_bf16_f32 v51, v38, v39
    v_exp_f32 v45, v45
    v_cvt_pk_bf16_f32 v52, v40, v41
    v_exp_f32 v46, v46
    v_cvt_pk_bf16_f32 v53, v42, v43
    v_exp_f32 v47, v47
    v_cvt_pk_bf16_f32 v54, v44, v45
    v_cvt_pk_bf16_f32 v55, v46, v47
    v_mfma_f32_32x32x16_bf16 v[32:47], v[168:171], v[152:155], 0
    v_exp_f32 v16, v16
    v_exp_f32 v17, v17
    v_exp_f32 v18, v18
    v_mfma_f32_32x32x16_bf16 v[32:47], v[172:175], v[156:159], v[32:47]
    v_exp_f32 v19, v19
    v_exp_f32 v20, v20
    v_exp_f32 v21, v21
    v_mfma_f32_32x32x16_bf16 v[80:95], v[200:203], v[48:51], v[80:95]
    v_exp_f32 v22, v22
    v_exp_f32 v23, v23
    v_exp_f32 v24, v24
    v_mfma_f32_32x32x16_bf16 v[80:95], v[204:207], v[52:55], v[80:95]
    s_waitcnt vmcnt(8)
    v_exp_f32 v25, v25
    v_cvt_pk_bf16_f32 v48, v16, v17
    v_exp_f32 v26, v26
    v_cvt_pk_bf16_f32 v49, v18, v19
    v_exp_f32 v27, v27
    v_cvt_pk_bf16_f32 v50, v20, v21
    v_exp_f32 v28, v28
    v_cvt_pk_bf16_f32 v51, v22, v23
    v_exp_f32 v29, v29
    v_cvt_pk_bf16_f32 v52, v24, v25
    v_exp_f32 v30, v30
    v_cvt_pk_bf16_f32 v53, v26, v27
    v_exp_f32 v31, v31
    v_cvt_pk_bf16_f32 v54, v28, v29
    v_cvt_pk_bf16_f32 v55, v30, v31
    v_mfma_f32_32x32x16_bf16 v[16:31], v[176:179], v[128:131], 0
    v_exp_f32 v32, v32
    v_exp_f32 v33, v33
    v_exp_f32 v34, v34
    v_mfma_f32_32x32x16_bf16 v[16:31], v[180:183], v[132:135], v[16:31]
    v_exp_f32 v35, v35
    v_exp_f32 v36, v36
    v_exp_f32 v37, v37
    v_mfma_f32_32x32x16_bf16 v[96:111], v[200:203], v[48:51], v[96:111]
    v_exp_f32 v38, v38
    v_exp_f32 v39, v39
    v_exp_f32 v40, v40
    v_mfma_f32_32x32x16_bf16 v[96:111], v[204:207], v[52:55], v[96:111]
    v_exp_f32 v41, v41
    v_cvt_pk_bf16_f32 v48, v32, v33
    v_exp_f32 v42, v42
    v_cvt_pk_bf16_f32 v49, v34, v35
    v_exp_f32 v43, v43
    v_cvt_pk_bf16_f32 v50, v36, v37
    v_exp_f32 v44, v44
    v_cvt_pk_bf16_f32 v51, v38, v39
    v_exp_f32 v45, v45
    v_cvt_pk_bf16_f32 v52, v40, v41
    v_exp_f32 v46, v46
    v_cvt_pk_bf16_f32 v53, v42, v43
    v_exp_f32 v47, v47
    v_cvt_pk_bf16_f32 v54, v44, v45
    v_cvt_pk_bf16_f32 v55, v46, v47
    v_mfma_f32_32x32x16_bf16 v[32:47], v[176:179], v[136:139], 0
    v_exp_f32 v16, v16
    v_exp_f32 v17, v17
    v_exp_f32 v18, v18
    v_mfma_f32_32x32x16_bf16 v[32:47], v[180:183], v[140:143], v[32:47]
    v_exp_f32 v19, v19
    v_exp_f32 v20, v20
    v_exp_f32 v21, v21
    v_mfma_f32_32x32x16_bf16 v[112:127], v[200:203], v[48:51], v[112:127]
    v_exp_f32 v22, v22
    v_exp_f32 v23, v23
    v_exp_f32 v24, v24
    v_mfma_f32_32x32x16_bf16 v[112:127], v[204:207], v[52:55], v[112:127]
    buffer_load_dwordx4 v[168:171], v8, s[40:43], s90 offen offset:0 sc1
    buffer_load_dwordx4 v[172:175], v8, s[40:43], s90 offen offset:1024 sc1
    buffer_load_dwordx4 v[200:203], v8, s[40:43], s90 offen offset:2048 sc1
    buffer_load_dwordx4 v[204:207], v8, s[40:43], s90 offen offset:3072 sc1
    v_exp_f32 v25, v25
    v_cvt_pk_bf16_f32 v48, v16, v17
    v_exp_f32 v26, v26
    v_cvt_pk_bf16_f32 v49, v18, v19
    v_exp_f32 v27, v27
    v_cvt_pk_bf16_f32 v50, v20, v21
    v_exp_f32 v28, v28
    v_cvt_pk_bf16_f32 v51, v22, v23
    v_exp_f32 v29, v29
    v_cvt_pk_bf16_f32 v52, v24, v25
    v_exp_f32 v30, v30
    v_cvt_pk_bf16_f32 v53, v26, v27
    v_exp_f32 v31, v31
    v_cvt_pk_bf16_f32 v54, v28, v29
    v_cvt_pk_bf16_f32 v55, v30, v31
    v_mfma_f32_32x32x16_bf16 v[16:31], v[176:179], v[144:147], 0
    s_add_u32 s90, s90, 4096
    v_exp_f32 v32, v32
    v_exp_f32 v33, v33
    v_exp_f32 v34, v34
    v_mfma_f32_32x32x16_bf16 v[16:31], v[180:183], v[148:151], v[16:31]
    v_exp_f32 v35, v35
    v_exp_f32 v36, v36
    v_exp_f32 v37, v37
    v_mfma_f32_32x32x16_bf16 v[64:79], v[208:211], v[48:51], v[64:79]
    v_exp_f32 v38, v38
    v_exp_f32 v39, v39
    v_exp_f32 v40, v40
    v_mfma_f32_32x32x16_bf16 v[64:79], v[212:215], v[52:55], v[64:79]
    v_exp_f32 v41, v41
    v_cvt_pk_bf16_f32 v48, v32, v33
    v_exp_f32 v42, v42
    v_cvt_pk_bf16_f32 v49, v34, v35
    v_exp_f32 v43, v43
    v_cvt_pk_bf16_f32 v50, v36, v37
    v_exp_f32 v44, v44
    v_cvt_pk_bf16_f32 v51, v38, v39
    v_exp_f32 v45, v45
    v_cvt_pk_bf16_f32 v52, v40, v41
    v_exp_f32 v46, v46
    v_cvt_pk_bf16_f32 v53, v42, v43
    v_exp_f32 v47, v47
    v_cvt_pk_bf16_f32 v54, v44, v45
    v_cvt_pk_bf16_f32 v55, v46, v47
    v_mfma_f32_32x32x16_bf16 v[32:47], v[176:179], v[152:155], 0
    v_exp_f32 v16, v16
    v_exp_f32 v17, v17
    v_exp_f32 v18, v18
    v_mfma_f32_32x32x16_bf16 v[32:47], v[180:183], v[156:159], v[32:47]
    v_exp_f32 v19, v19
    v_exp_f32 v20, v20
    v_exp_f32 v21, v21
    v_mfma_f32_32x32x16_bf16 v[80:95], v[208:211], v[48:51], v[80:95]
    v_exp_f32 v22, v22
    v_exp_f32 v23, v23
    v_exp_f32 v24, v24
    v_mfma_f32_32x32x16_bf16 v[80:95], v[212:215], v[52:55], v[80:95]
    s_waitcnt vmcnt(8)
    v_exp_f32 v25, v25
    v_cvt_pk_bf16_f32 v48, v16, v17
    v_exp_f32 v26, v26
    v_cvt_pk_bf16_f32 v49, v18, v19
    v_exp_f32 v27, v27
    v_cvt_pk_bf16_f32 v50, v20, v21
    v_exp_f32 v28, v28
    v_cvt_pk_bf16_f32 v51, v22, v23
    v_exp_f32 v29, v29
    v_cvt_pk_bf16_f32 v52, v24, v25
    v_exp_f32 v30, v30
    v_cvt_pk_bf16_f32 v53, v26, v27
    v_exp_f32 v31, v31
    v_cvt_pk_bf16_f32 v54, v28, v29
    v_cvt_pk_bf16_f32 v55, v30, v31
    v_mfma_f32_32x32x16_bf16 v[16:31], v[184:187], v[128:131], 0
    v_exp_f32 v32, v32
    v_exp_f32 v33, v33
    v_exp_f32 v34, v34
    v_mfma_f32_32x32x16_bf16 v[16:31], v[188:191], v[132:135], v[16:31]
    v_exp_f32 v35, v35
    v_exp_f32 v36, v36
    v_exp_f32 v37, v37
    v_mfma_f32_32x32x16_bf16 v[96:111], v[208:211], v[48:51], v[96:111]
    v_exp_f32 v38, v38
    v_exp_f32 v39, v39
    v_exp_f32 v40, v40
    v_mfma_f32_32x32x16_bf16 v[96:111], v[212:215], v[52:55], v[96:111]
    v_exp_f32 v41, v41
    v_cvt_pk_bf16_f32 v48, v32, v33
    v_exp_f32 v42, v42
    v_cvt_pk_bf16_f32 v49, v34, v35
    v_exp_f32 v43, v43
    v_cvt_pk_bf16_f32 v50, v36, v37
    v_exp_f32 v44, v44
    v_cvt_pk_bf16_f32 v51, v38, v39
    v_exp_f32 v45, v45
    v_cvt_pk_bf16_f32 v52, v40, v41
    v_exp_f32 v46, v46
    v_cvt_pk_bf16_f32 v53, v42, v43
    v_exp_f32 v47, v47
    v_cvt_pk_bf16_f32 v54, v44, v45
    v_cvt_pk_bf16_f32 v55, v46, v47
    v_mfma_f32_32x32x16_bf16 v[32:47], v[184:187], v[136:139], 0
    v_exp_f32 v16, v16
    v_exp_f32 v17, v17
    v_exp_f32 v18, v18
    v_mfma_f32_32x32x16_bf16 v[32:47], v[188:191], v[140:143], v[32:47]
    v_exp_f32 v19, v19
    v_exp_f32 v20, v20
    v_exp_f32 v21, v21
    v_mfma_f32_32x32x16_bf16 v[112:127], v[208:211], v[48:51], v[112:127]
    v_exp_f32 v22, v22
    v_exp_f32 v23, v23
    v_exp_f32 v24, v24
    v_mfma_f32_32x32x16_bf16 v[112:127], v[212:215], v[52:55], v[112:127]
    buffer_load_dwordx4 v[176:179], v8, s[40:43], s90 offen offset:0 sc1
    buffer_load_dwordx4 v[180:183], v8, s[40:43], s90 offen offset:1024 sc1
    buffer_load_dwordx4 v[208:211], v8, s[40:43], s90 offen offset:2048 sc1
    buffer_load_dwordx4 v[212:215], v8, s[40:43], s90 offen offset:3072 sc1
    v_exp_f32 v25, v25
    v_cvt_pk_bf16_f32 v48, v16, v17
    v_exp_f32 v26, v26
    v_cvt_pk_bf16_f32 v49, v18, v19
    v_exp_f32 v27, v27
    v_cvt_pk_bf16_f32 v50, v20, v21
    v_exp_f32 v28, v28
    v_cvt_pk_bf16_f32 v51, v22, v23
    v_exp_f32 v29, v29
    v_cvt_pk_bf16_f32 v52, v24, v25
    v_exp_f32 v30, v30
    v_cvt_pk_bf16_f32 v53, v26, v27
    v_exp_f32 v31, v31
    v_cvt_pk_bf16_f32 v54, v28, v29
    v_cvt_pk_bf16_f32 v55, v30, v31
    v_mfma_f32_32x32x16_bf16 v[16:31], v[184:187], v[144:147], 0
    s_add_u32 s90, s90, 4096
    v_exp_f32 v32, v32
    v_exp_f32 v33, v33
    v_exp_f32 v34, v34
    v_mfma_f32_32x32x16_bf16 v[16:31], v[188:191], v[148:151], v[16:31]
    v_exp_f32 v35, v35
    v_exp_f32 v36, v36
    v_exp_f32 v37, v37
    v_mfma_f32_32x32x16_bf16 v[64:79], v[216:219], v[48:51], v[64:79]
    v_exp_f32 v38, v38
    v_exp_f32 v39, v39
    v_exp_f32 v40, v40
    v_mfma_f32_32x32x16_bf16 v[64:79], v[220:223], v[52:55], v[64:79]
    v_exp_f32 v41, v41
    v_cvt_pk_bf16_f32 v48, v32, v33
    v_exp_f32 v42, v42
    v_cvt_pk_bf16_f32 v49, v34, v35
    v_exp_f32 v43, v43
    v_cvt_pk_bf16_f32 v50, v36, v37
    v_exp_f32 v44, v44
    v_cvt_pk_bf16_f32 v51, v38, v39
    v_exp_f32 v45, v45
    v_cvt_pk_bf16_f32 v52, v40, v41
    v_exp_f32 v46, v46
    v_cvt_pk_bf16_f32 v53, v42, v43
    v_exp_f32 v47, v47
    v_cvt_pk_bf16_f32 v54, v44, v45
    v_cvt_pk_bf16_f32 v55, v46, v47
    v_mfma_f32_32x32x16_bf16 v[32:47], v[184:187], v[152:155], 0
    v_exp_f32 v16, v16
    v_exp_f32 v17, v17
    v_exp_f32 v18, v18
    v_mfma_f32_32x32x16_bf16 v[32:47], v[188:191], v[156:159], v[32:47]
    v_exp_f32 v19, v19
    v_exp_f32 v20, v20
    v_exp_f32 v21, v21
    v_mfma_f32_32x32x16_bf16 v[80:95], v[216:219], v[48:51], v[80:95]
    v_exp_f32 v22, v22
    v_exp_f32 v23, v23
    v_exp_f32 v24, v24
    v_mfma_f32_32x32x16_bf16 v[80:95], v[220:223], v[52:55], v[80:95]
    s_waitcnt vmcnt(8)
    v_exp_f32 v25, v25
    v_cvt_pk_bf16_f32 v48, v16, v17
    v_exp_f32 v26, v26
    v_cvt_pk_bf16_f32 v49, v18, v19
    v_exp_f32 v27, v27
    v_cvt_pk_bf16_f32 v50, v20, v21
    v_exp_f32 v28, v28
    v_cvt_pk_bf16_f32 v51, v22, v23
    v_exp_f32 v29, v29
    v_cvt_pk_bf16_f32 v52, v24, v25
    v_exp_f32 v30, v30
    v_cvt_pk_bf16_f32 v53, v26, v27
    v_exp_f32 v31, v31
    v_cvt_pk_bf16_f32 v54, v28, v29
    v_cvt_pk_bf16_f32 v55, v30, v31
    v_mfma_f32_32x32x16_bf16 v[16:31], v[160:163], v[128:131], 0
    s_sub_u32 s78, s78, 1
    v_exp_f32 v32, v32
    v_exp_f32 v33, v33
    v_exp_f32 v34, v34
    v_mfma_f32_32x32x16_bf16 v[16:31], v[164:167], v[132:135], v[16:31]
    s_cmp_lg_u32 s78, 0
    v_exp_f32 v35, v35
    v_exp_f32 v36, v36
    v_exp_f32 v37, v37
    v_mfma_f32_32x32x16_bf16 v[96:111], v[216:219], v[48:51], v[96:111]
    v_exp_f32 v38, v38
    v_exp_f32 v39, v39
    v_exp_f32 v40, v40
    v_mfma_f32_32x32x16_bf16 v[96:111], v[220:223], v[52:55], v[96:111]
    v_exp_f32 v41, v41
    v_cvt_pk_bf16_f32 v48, v32, v33
    v_exp_f32 v42, v42
    v_cvt_pk_bf16_f32 v49, v34, v35
    v_exp_f32 v43, v43
    v_cvt_pk_bf16_f32 v50, v36, v37
    v_exp_f32 v44, v44
    v_cvt_pk_bf16_f32 v51, v38, v39
    v_exp_f32 v45, v45
    v_cvt_pk_bf16_f32 v52, v40, v41
    v_exp_f32 v46, v46
    v_cvt_pk_bf16_f32 v53, v42, v43
    v_exp_f32 v47, v47
    v_cvt_pk_bf16_f32 v54, v44, v45
    s_cbranch_scc1 L_attn_loop
    v_cvt_pk_bf16_f32 v55, v46, v47
    v_mfma_f32_32x32x16_bf16 v[32:47], v[160:163], v[136:139], 0
    v_exp_f32 v16, v16
    v_exp_f32 v17, v17
    v_exp_f32 v18, v18
    v_mfma_f32_32x32x16_bf16 v[32:47], v[164:167], v[140:143], v[32:47]
    v_exp_f32 v19, v19
    v_exp_f32 v20, v20
    v_exp_f32 v21, v21
    v_mfma_f32_32x32x16_bf16 v[112:127], v[216:219], v[48:51], v[112:127]
    v_exp_f32 v22, v22
    v_exp_f32 v23, v23
    v_exp_f32 v24, v24
    v_mfma_f32_32x32x16_bf16 v[112:127], v[220:223], v[52:55], v[112:127]
    buffer_load_dwordx4 v[184:187], v8, s[40:43], s90 offen offset:0 sc1
    buffer_load_dwordx4 v[188:191], v8, s[40:43], s90 offen offset:1024 sc1
    buffer_load_dwordx4 v[216:219], v8, s[40:43], s90 offen offset:2048 sc1
    buffer_load_dwordx4 v[220:223], v8, s[40:43], s90 offen offset:3072 sc1
    v_exp_f32 v25, v25
    v_cvt_pk_bf16_f32 v48, v16, v17
    v_exp_f32 v26, v26
    v_cvt_pk_bf16_f32 v49, v18, v19
    v_exp_f32 v27, v27
    v_cvt_pk_bf16_f32 v50, v20, v21
    v_exp_f32 v28, v28
    v_cvt_pk_bf16_f32 v51, v22, v23
    v_exp_f32 v29, v29
    v_cvt_pk_bf16_f32 v52, v24, v25
    v_exp_f32 v30, v30
    v_cvt_pk_bf16_f32 v53, v26, v27
    v_exp_f32 v31, v31
    v_cvt_pk_bf16_f32 v54, v28, v29
    v_cvt_pk_bf16_f32 v55, v30, v31
    v_mfma_f32_32x32x16_bf16 v[16:31], v[160:163], v[144:147], 0
    v_exp_f32 v32, v32
    v_exp_f32 v33, v33
    v_exp_f32 v34, v34
    v_mfma_f32_32x32x16_bf16 v[16:31], v[164:167], v[148:151], v[16:31]
    v_exp_f32 v35, v35
    v_exp_f32 v36, v36
    v_exp_f32 v37, v37
    v_mfma_f32_32x32x16_bf16 v[64:79], v[192:195], v[48:51], v[64:79]
    v_exp_f32 v38, v38
    v_exp_f32 v39, v39
    v_exp_f32 v40, v40
    v_mfma_f32_32x32x16_bf16 v[64:79], v[196:199], v[52:55], v[64:79]
    v_exp_f32 v41, v41
    v_cvt_pk_bf16_f32 v48, v32, v33
    v_exp_f32 v42, v42
    v_cvt_pk_bf16_f32 v49, v34, v35
    v_exp_f32 v43, v43
    v_cvt_pk_bf16_f32 v50, v36, v37
    v_exp_f32 v44, v44
    v_cvt_pk_bf16_f32 v51, v38, v39
    v_exp_f32 v45, v45
    v_cvt_pk_bf16_f32 v52, v40, v41
    v_exp_f32 v46, v46
    v_cvt_pk_bf16_f32 v53, v42, v43
    v_exp_f32 v47, v47
    v_cvt_pk_bf16_f32 v54, v44, v45
    v_cvt_pk_bf16_f32 v55, v46, v47
    v_mfma_f32_32x32x16_bf16 v[32:47], v[160:163], v[152:155], 0
    v_exp_f32 v16, v16
    v_exp_f32 v17, v17
    v_exp_f32 v18, v18
    v_mfma_f32_32x32x16_bf16 v[32:47], v[164:167], v[156:159], v[32:47]
    v_exp_f32 v19, v19
    v_exp_f32 v20, v20
    v_exp_f32 v21, v21
    v_mfma_f32_32x32x16_bf16 v[80:95], v[192:195], v[48:51], v[80:95]
    v_exp_f32 v22, v22
    v_exp_f32 v23, v23
    v_exp_f32 v24, v24
    v_mfma_f32_32x32x16_bf16 v[80:95], v[196:199], v[52:55], v[80:95]
    s_waitcnt vmcnt(8)
    v_exp_f32 v25, v25
    v_cvt_pk_bf16_f32 v48, v16, v17
    v_exp_f32 v26, v26
    v_cvt_pk_bf16_f32 v49, v18, v19
    v_exp_f32 v27, v27
    v_cvt_pk_bf16_f32 v50, v20, v21
    v_exp_f32 v28, v28
    v_cvt_pk_bf16_f32 v51, v22, v23
    v_exp_f32 v29, v29
    v_cvt_pk_bf16_f32 v52, v24, v25
    v_exp_f32 v30, v30
    v_cvt_pk_bf16_f32 v53, v26, v27
    v_exp_f32 v31, v31
    v_cvt_pk_bf16_f32 v54, v28, v29
    v_cvt_pk_bf16_f32 v55, v30, v31
    v_mfma_f32_32x32x16_bf16 v[16:31], v[168:171], v[128:131], 0
    v_exp_f32 v32, v32
    v_exp_f32 v33, v33
    v_exp_f32 v34, v34
    v_mfma_f32_32x32x16_bf16 v[16:31], v[172:175], v[132:135], v[16:31]
    v_exp_f32 v35, v35
    v_exp_f32 v36, v36
    v_exp_f32 v37, v37
    v_mfma_f32_32x32x16_bf16 v[96:111], v[192:195], v[48:51], v[96:111]
    v_exp_f32 v38, v38
    v_exp_f32 v39, v39
    v_exp_f32 v40, v40
    v_mfma_f32_32x32x16_bf16 v[96:111], v[196:199], v[52:55], v[96:111]
    v_exp_f32 v41, v41
    v_cvt_pk_bf16_f32 v48, v32, v33
    v_exp_f32 v42, v42
    v_cvt_pk_bf16_f32 v49, v34, v35
    v_exp_f32 v43, v43
    v_cvt_pk_bf16_f32 v50, v36, v37
    v_exp_f32 v44, v44
    v_cvt_pk_bf16_f32 v51, v38, v39
    v_exp_f32 v45, v45
    v_cvt_pk_bf16_f32 v52, v40, v41
    v_exp_f32 v46, v46
    v_cvt_pk_bf16_f32 v53, v42, v43
    v_exp_f32 v47, v47
    v_cvt_pk_bf16_f32 v54, v44, v45
    v_cvt_pk_bf16_f32 v55, v46, v47
    v_mfma_f32_32x32x16_bf16 v[32:47], v[168:171], v[136:139], 0
    v_exp_f32 v16, v16
    v_exp_f32 v17, v17
    v_exp_f32 v18, v18
    v_mfma_f32_32x32x16_bf16 v[32:47], v[172:175], v[140:143], v[32:47]
    v_exp_f32 v19, v19
    v_exp_f32 v20, v20
    v_exp_f32 v21, v21
    v_mfma_f32_32x32x16_bf16 v[112:127], v[192:195], v[48:51], v[112:127]
    v_exp_f32 v22, v22
    v_exp_f32 v23, v23
    v_exp_f32 v24, v24
    v_mfma_f32_32x32x16_bf16 v[112:127], v[196:199], v[52:55], v[112:127]
    v_exp_f32 v25, v25
    v_cvt_pk_bf16_f32 v48, v16, v17
    v_exp_f32 v26, v26
    v_cvt_pk_bf16_f32 v49, v18, v19
    v_exp_f32 v27, v27
    v_cvt_pk_bf16_f32 v50, v20, v21
    v_exp_f32 v28, v28
    v_cvt_pk_bf16_f32 v51, v22, v23
    v_exp_f32 v29, v29
    v_cvt_pk_bf16_f32 v52, v24, v25
    v_exp_f32 v30, v30
    v_cvt_pk_bf16_f32 v53, v26, v27
    v_exp_f32 v31, v31
    v_cvt_pk_bf16_f32 v54, v28, v29
    v_cvt_pk_bf16_f32 v55, v30, v31
    v_mfma_f32_32x32x16_bf16 v[16:31], v[168:171], v[144:147], 0
    v_exp_f32 v32, v32
    v_exp_f32 v33, v33
    v_exp_f32 v34, v34
    v_mfma_f32_32x32x16_bf16 v[16:31], v[172:175], v[148:151], v[16:31]
    v_exp_f32 v35, v35
    v_exp_f32 v36, v36
    v_exp_f32 v37, v37
    v_mfma_f32_32x32x16_bf16 v[64:79], v[200:203], v[48:51], v[64:79]
    v_exp_f32 v38, v38
    v_exp_f32 v39, v39
    v_exp_f32 v40, v40
    v_mfma_f32_32x32x16_bf16 v[64:79], v[204:207], v[52:55], v[64:79]
    v_exp_f32 v41, v41
    v_cvt_pk_bf16_f32 v48, v32, v33
    v_exp_f32 v42, v42
    v_cvt_pk_bf16_f32 v49, v34, v35
    v_exp_f32 v43, v43
    v_cvt_pk_bf16_f32 v50, v36, v37
    v_exp_f32 v44, v44
    v_cvt_pk_bf16_f32 v51, v38, v39
    v_exp_f32 v45, v45
    v_cvt_pk_bf16_f32 v52, v40, v41
    v_exp_f32 v46, v46
    v_cvt_pk_bf16_f32 v53, v42, v43
    v_exp_f32 v47, v47
    v_cvt_pk_bf16_f32 v54, v44, v45
    v_cvt_pk_bf16_f32 v55, v46, v47
    v_mfma_f32_32x32x16_bf16 v[32:47], v[168:171], v[152:155], 0
    v_exp_f32 v16, v16
    v_exp_f32 v17, v17
    v_exp_f32 v18, v18
    v_mfma_f32_32x32x16_bf16 v[32:47], v[172:175], v[156:159], v[32:47]
    v_exp_f32 v19, v19
    v_exp_f32 v20, v20
    v_exp_f32 v21, v21
    v_mfma_f32_32x32x16_bf16 v[80:95], v[200:203], v[48:51], v[80:95]
    v_exp_f32 v22, v22
    v_exp_f32 v23, v23
    v_exp_f32 v24, v24
    v_mfma_f32_32x32x16_bf16 v[80:95], v[204:207], v[52:55], v[80:95]
    s_waitcnt vmcnt(4)
    v_exp_f32 v25, v25
    v_cvt_pk_bf16_f32 v48, v16, v17
    v_exp_f32 v26, v26
    v_cvt_pk_bf16_f32 v49, v18, v19
    v_exp_f32 v27, v27
    v_cvt_pk_bf16_f32 v50, v20, v21
    v_exp_f32 v28, v28
    v_cvt_pk_bf16_f32 v51, v22, v23
    v_exp_f32 v29, v29
    v_cvt_pk_bf16_f32 v52, v24, v25
    v_exp_f32 v30, v30
    v_cvt_pk_bf16_f32 v53, v26, v27
    v_exp_f32 v31, v31
    v_cvt_pk_bf16_f32 v54, v28, v29
    v_cvt_pk_bf16_f32 v55, v30, v31
    v_mfma_f32_32x32x16_bf16 v[16:31], v[176:179], v[128:131], 0
    v_exp_f32 v32, v32
    v_exp_f32 v33, v33
    v_exp_f32 v34, v34
    v_mfma_f32_32x32x16_bf16 v[16:31], v[180:183], v[132:135], v[16:31]
    v_exp_f32 v35, v35
    v_exp_f32 v36, v36
    v_exp_f32 v37, v37
    v_mfma_f32_32x32x16_bf16 v[96:111], v[200:203], v[48:51], v[96:111]
    v_exp_f32 v38, v38
    v_exp_f32 v39, v39
    v_exp_f32 v40, v40
    v_mfma_f32_32x32x16_bf16 v[96:111], v[204:207], v[52:55], v[96:111]
    v_exp_f32 v41, v41
    v_cvt_pk_bf16_f32 v48, v32, v33
    v_exp_f32 v42, v42
    v_cvt_pk_bf16_f32 v49, v34, v35
    v_exp_f32 v43, v43
    v_cvt_pk_bf16_f32 v50, v36, v37
    v_exp_f32 v44, v44
    v_cvt_pk_bf16_f32 v51, v38, v39
    v_exp_f32 v45, v45
    v_cvt_pk_bf16_f32 v52, v40, v41
    v_exp_f32 v46, v46
    v_cvt_pk_bf16_f32 v53, v42, v43
    v_exp_f32 v47, v47
    v_cvt_pk_bf16_f32 v54, v44, v45
    v_cvt_pk_bf16_f32 v55, v46, v47
    v_mfma_f32_32x32x16_bf16 v[32:47], v[176:179], v[136:139], 0
    v_exp_f32 v16, v16
    v_exp_f32 v17, v17
    v_exp_f32 v18, v18
    v_mfma_f32_32x32x16_bf16 v[32:47], v[180:183], v[140:143], v[32:47]
    v_exp_f32 v19, v19
    v_exp_f32 v20, v20
    v_exp_f32 v21, v21
    v_mfma_f32_32x32x16_bf16 v[112:127], v[200:203], v[48:51], v[112:127]
    v_exp_f32 v22, v22
    v_exp_f32 v23, v23
    v_exp_f32 v24, v24
    v_mfma_f32_32x32x16_bf16 v[112:127], v[204:207], v[52:55], v[112:127]
    v_exp_f32 v25, v25
    v_cvt_pk_bf16_f32 v48, v16, v17
    v_exp_f32 v26, v26
    v_cvt_pk_bf16_f32 v49, v18, v19
    v_exp_f32 v27, v27
    v_cvt_pk_bf16_f32 v50, v20, v21
    v_exp_f32 v28, v28
    v_cvt_pk_bf16_f32 v51, v22, v23
    v_exp_f32 v29, v29
    v_cvt_pk_bf16_f32 v52, v24, v25
    v_exp_f32 v30, v30
    v_cvt_pk_bf16_f32 v53, v26, v27
    v_exp_f32 v31, v31
    v_cvt_pk_bf16_f32 v54, v28, v29
    v_cvt_pk_bf16_f32 v55, v30, v31
    v_mfma_f32_32x32x16_bf16 v[16:31], v[176:179], v[144:147], 0
    v_exp_f32 v32, v32
    v_exp_f32 v33, v33
    v_exp_f32 v34, v34
    v_mfma_f32_32x32x16_bf16 v[16:31], v[180:183], v[148:151], v[16:31]
    v_exp_f32 v35, v35
    v_exp_f32 v36, v36
    v_exp_f32 v37, v37
    v_mfma_f32_32x32x16_bf16 v[64:79], v[208:211], v[48:51], v[64:79]
    v_exp_f32 v38, v38
    v_exp_f32 v39, v39
    v_exp_f32 v40, v40
    v_mfma_f32_32x32x16_bf16 v[64:79], v[212:215], v[52:55], v[64:79]
    v_exp_f32 v41, v41
    v_cvt_pk_bf16_f32 v48, v32, v33
    v_exp_f32 v42, v42
    v_cvt_pk_bf16_f32 v49, v34, v35
    v_exp_f32 v43, v43
    v_cvt_pk_bf16_f32 v50, v36, v37
    v_exp_f32 v44, v44
    v_cvt_pk_bf16_f32 v51, v38, v39
    v_exp_f32 v45, v45
    v_cvt_pk_bf16_f32 v52, v40, v41
    v_exp_f32 v46, v46
    v_cvt_pk_bf16_f32 v53, v42, v43
    v_exp_f32 v47, v47
    v_cvt_pk_bf16_f32 v54, v44, v45
    v_cvt_pk_bf16_f32 v55, v46, v47
    v_mfma_f32_32x32x16_bf16 v[32:47], v[176:179], v[152:155], 0
    v_exp_f32 v16, v16
    v_exp_f32 v17, v17
    v_exp_f32 v18, v18
    v_mfma_f32_32x32x16_bf16 v[32:47], v[180:183], v[156:159], v[32:47]
    v_exp_f32 v19, v19
    v_exp_f32 v20, v20
    v_exp_f32 v21, v21
    v_mfma_f32_32x32x16_bf16 v[80:95], v[208:211], v[48:51], v[80:95]
    v_exp_f32 v22, v22
    v_exp_f32 v23, v23
    v_exp_f32 v24, v24
    v_mfma_f32_32x32x16_bf16 v[80:95], v[212:215], v[52:55], v[80:95]
    s_waitcnt vmcnt(0)
    v_exp_f32 v25, v25
    v_cvt_pk_bf16_f32 v48, v16, v17
    v_exp_f32 v26, v26
    v_cvt_pk_bf16_f32 v49, v18, v19
    v_exp_f32 v27, v27
    v_cvt_pk_bf16_f32 v50, v20, v21
    v_exp_f32 v28, v28
    v_cvt_pk_bf16_f32 v51, v22, v23
    v_exp_f32 v29, v29
    v_cvt_pk_bf16_f32 v52, v24, v25
    v_exp_f32 v30, v30
    v_cvt_pk_bf16_f32 v53, v26, v27
    v_exp_f32 v31, v31
    v_cvt_pk_bf16_f32 v54, v28, v29
    v_cvt_pk_bf16_f32 v55, v30, v31
    v_mfma_f32_32x32x16_bf16 v[16:31], v[184:187], v[128:131], 0
    v_exp_f32 v32, v32
    v_exp_f32 v33, v33
    v_exp_f32 v34, v34
    v_mfma_f32_32x32x16_bf16 v[16:31], v[188:191], v[132:135], v[16:31]
    v_exp_f32 v35, v35
    v_exp_f32 v36, v36
    v_exp_f32 v37, v37
    v_mfma_f32_32x32x16_bf16 v[96:111], v[208:211], v[48:51], v[96:111]
    v_exp_f32 v38, v38
    v_exp_f32 v39, v39
    v_exp_f32 v40, v40
    v_mfma_f32_32x32x16_bf16 v[96:111], v[212:215], v[52:55], v[96:111]
    v_exp_f32 v41, v41
    v_cvt_pk_bf16_f32 v48, v32, v33
    v_exp_f32 v42, v42
    v_cvt_pk_bf16_f32 v49, v34, v35
    v_exp_f32 v43, v43
    v_cvt_pk_bf16_f32 v50, v36, v37
    v_exp_f32 v44, v44
    v_cvt_pk_bf16_f32 v51, v38, v39
    v_exp_f32 v45, v45
    v_cvt_pk_bf16_f32 v52, v40, v41
    v_exp_f32 v46, v46
    v_cvt_pk_bf16_f32 v53, v42, v43
    v_exp_f32 v47, v47
    v_cvt_pk_bf16_f32 v54, v44, v45
    v_cvt_pk_bf16_f32 v55, v46, v47
    v_mfma_f32_32x32x16_bf16 v[32:47], v[184:187], v[136:139], 0
    v_exp_f32 v16, v16
    v_exp_f32 v17, v17
    v_exp_f32 v18, v18
    v_mfma_f32_32x32x16_bf16 v[32:47], v[188:191], v[140:143], v[32:47]
    v_exp_f32 v19, v19
    v_exp_f32 v20, v20
    v_exp_f32 v21, v21
    v_mfma_f32_32x32x16_bf16 v[112:127], v[208:211], v[48:51], v[112:127]
    v_exp_f32 v22, v22
    v_exp_f32 v23, v23
    v_exp_f32 v24, v24
    v_mfma_f32_32x32x16_bf16 v[112:127], v[212:215], v[52:55], v[112:127]
    v_exp_f32 v25, v25
    v_cvt_pk_bf16_f32 v48, v16, v17
    v_exp_f32 v26, v26
    v_cvt_pk_bf16_f32 v49, v18, v19
    v_exp_f32 v27, v27
    v_cvt_pk_bf16_f32 v50, v20, v21
    v_exp_f32 v28, v28
    v_cvt_pk_bf16_f32 v51, v22, v23
    v_exp_f32 v29, v29
    v_cvt_pk_bf16_f32 v52, v24, v25
    v_exp_f32 v30, v30
    v_cvt_pk_bf16_f32 v53, v26, v27
    v_exp_f32 v31, v31
    v_cvt_pk_bf16_f32 v54, v28, v29
    v_cvt_pk_bf16_f32 v55, v30, v31
    v_mfma_f32_32x32x16_bf16 v[16:31], v[184:187], v[144:147], 0
    v_exp_f32 v32, v32
    v_exp_f32 v33, v33
    v_exp_f32 v34, v34
    v_mfma_f32_32x32x16_bf16 v[16:31], v[188:191], v[148:151], v[16:31]
    v_exp_f32 v35, v35
    v_exp_f32 v36, v36
    v_exp_f32 v37, v37
    v_mfma_f32_32x32x16_bf16 v[64:79], v[216:219], v[48:51], v[64:79]
    v_exp_f32 v38, v38
    v_exp_f32 v39, v39
    v_exp_f32 v40, v40
    v_mfma_f32_32x32x16_bf16 v[64:79], v[220:223], v[52:55], v[64:79]
    v_exp_f32 v41, v41
    v_cvt_pk_bf16_f32 v48, v32, v33
    v_exp_f32 v42, v42
    v_cvt_pk_bf16_f32 v49, v34, v35
    v_exp_f32 v43, v43
    v_cvt_pk_bf16_f32 v50, v36, v37
    v_exp_f32 v44, v44
    v_cvt_pk_bf16_f32 v51, v38, v39
    v_exp_f32 v45, v45
    v_cvt_pk_bf16_f32 v52, v40, v41
    v_exp_f32 v46, v46
    v_cvt_pk_bf16_f32 v53, v42, v43
    v_exp_f32 v47, v47
    v_cvt_pk_bf16_f32 v54, v44, v45
    v_cvt_pk_bf16_f32 v55, v46, v47
    v_mfma_f32_32x32x16_bf16 v[32:47], v[184:187], v[152:155], 0
    v_exp_f32 v16, v16
    v_exp_f32 v17, v17
    v_exp_f32 v18, v18
    v_mfma_f32_32x32x16_bf16 v[32:47], v[188:191], v[156:159], v[32:47]
    v_exp_f32 v19, v19
    v_exp_f32 v20, v20
    v_exp_f32 v21, v21
    v_mfma_f32_32x32x16_bf16 v[80:95], v[216:219], v[48:51], v[80:95]
    v_exp_f32 v22, v22
    v_exp_f32 v23, v23
    v_exp_f32 v24, v24
    v_mfma_f32_32x32x16_bf16 v[80:95], v[220:223], v[52:55], v[80:95]
    ds_write_b128 v224, v[64:67] offset:0
    ds_write_b128 v224, v[68:71] offset:1024
    ds_write_b128 v224, v[72:75] offset:2048
    ds_write_b128 v224, v[76:79] offset:3072
    v_exp_f32 v25, v25
    v_cvt_pk_bf16_f32 v48, v16, v17
    v_exp_f32 v26, v26
    v_cvt_pk_bf16_f32 v49, v18, v19
    v_exp_f32 v27, v27
    v_cvt_pk_bf16_f32 v50, v20, v21
    v_exp_f32 v28, v28
    v_cvt_pk_bf16_f32 v51, v22, v23
    v_exp_f32 v29, v29
    v_cvt_pk_bf16_f32 v52, v24, v25
    v_exp_f32 v30, v30
    v_cvt_pk_bf16_f32 v53, v26, v27
    v_exp_f32 v31, v31
    v_cvt_pk_bf16_f32 v54, v28, v29
    v_cvt_pk_bf16_f32 v55, v30, v31
    v_exp_f32 v32, v32
    v_exp_f32 v33, v33
    v_mfma_f32_32x32x16_bf16 v[96:111], v[216:219], v[48:51], v[96:111]
    v_exp_f32 v34, v34
    v_exp_f32 v35, v35
    v_exp_f32 v36, v36
    v_mfma_f32_32x32x16_bf16 v[96:111], v[220:223], v[52:55], v[96:111]
    ds_write_b128 v225, v[80:83] offset:4096
    ds_write_b128 v225, v[84:87] offset:5120
    ds_write_b128 v225, v[88:91] offset:6144
    ds_write_b128 v225, v[92:95] offset:7168
    v_exp_f32 v37, v37
    v_exp_f32 v38, v38
    v_cvt_pk_bf16_f32 v48, v32, v33
    v_exp_f32 v39, v39
    v_exp_f32 v40, v40
    v_cvt_pk_bf16_f32 v49, v34, v35
    v_exp_f32 v41, v41
    v_exp_f32 v42, v42
    v_cvt_pk_bf16_f32 v50, v36, v37
    ds_write_b128 v226, v[96:99] offset:8192
    ds_write_b128 v226, v[100:103] offset:9216
    ds_write_b128 v226, v[104:107] offset:10240
    ds_write_b128 v226, v[108:111] offset:11264
    s_mov_b64 exec, 1
    ds_add_u32 v10, v11
    s_mov_b64 exec, -1
    v_exp_f32 v43, v43
    v_exp_f32 v44, v44
    v_cvt_pk_bf16_f32 v51, v38, v39
    v_exp_f32 v45, v45
    v_cvt_pk_bf16_f32 v52, v40, v41
    v_exp_f32 v46, v46
    v_cvt_pk_bf16_f32 v53, v42, v43
    v_exp_f32 v47, v47
    v_cvt_pk_bf16_f32 v54, v44, v45
    v_cvt_pk_bf16_f32 v55, v46, v47
    v_mfma_f32_32x32x16_bf16 v[112:127], v[216:219], v[48:51], v[112:127]
    s_nop 0
    v_mfma_f32_32x32x16_bf16 v[112:127], v[220:223], v[52:55], v[112:127]
    s_mov_b32 s78, 33554432
    ds_read_b32 v4, v10
L_w4:
    s_waitcnt lgkmcnt(0)
    v_readfirstlane_b32 s74, v4
    s_nop 0
    s_cmp_ge_u32 s74, 4
    s_cbranch_scc1 L_w4_ok
    s_sub_u32 s78, s78, 1
    s_cbranch_scc1 L_w4_ok
    ds_read_b32 v4, v10
    s_branch L_w4
L_w4_ok:
    ds_read_b128 v[140:143], v227 offset:3072
    ds_read_b128 v[156:159], v227 offset:7168
    ds_read_b128 v[172:175], v227 offset:11264
    ds_read_b128 v[128:131], v227 offset:0
    ds_read_b128 v[144:147], v227 offset:4096
    ds_read_b128 v[160:163], v227 offset:8192
    ds_read_b128 v[132:135], v227 offset:1024
    ds_read_b128 v[148:151], v227 offset:5120
    ds_read_b128 v[164:167], v227 offset:9216
    ds_read_b128 v[136:139], v227 offset:2048
    ds_read_b128 v[152:155], v227 offset:6144
    ds_read_b128 v[168:171], v227 offset:10240
    s_waitcnt lgkmcnt(10)
    v_add_f32 v140, v140, v156
    v_add_f32 v141, v141, v157
    v_add_f32 v142, v142, v158
    v_add_f32 v143, v143, v159
    s_waitcnt lgkmcnt(9)
    v_add_f32 v124, v124, v172
    v_add_f32 v125, v125, v173
    v_add_f32 v126, v126, v174
    v_add_f32 v127, v127, v175
    v_add_f32 v124, v124, v140
    v_add_f32 v125, v125, v141
    v_add_f32 v126, v126, v142
    v_add_f32 v127, v127, v143
    v_mov_b32 v4, v124
    v_mov_b32 v5, v124
    s_nop 1
    v_permlane32_swap_b32 v4, v5
    v_rcp_f32 v5, v5
    s_nop 0
    v_cndmask_b32 v4, v5, 0, s[94:95]
    v_mul_f32 v124, v124, v4
    v_mul_f32 v125, v125, v4
    v_mul_f32 v126, v126, v4
    v_mul_f32 v127, v127, v4
    v_cvt_pk_bf16_f32 v54, v124, v125
    v_cvt_pk_bf16_f32 v55, v126, v127
    s_waitcnt lgkmcnt(7)
    v_add_f32 v128, v128, v144
    v_add_f32 v129, v129, v145
    v_add_f32 v130, v130, v146
    v_add_f32 v131, v131, v147
    s_waitcnt lgkmcnt(6)
    v_add_f32 v112, v112, v160
    v_add_f32 v113, v113, v161
    v_add_f32 v114, v114, v162
    v_add_f32 v115, v115, v163
    v_add_f32 v112, v112, v128
    v_add_f32 v113, v113, v129
    v_add_f32 v114, v114, v130
    v_add_f32 v115, v115, v131
    v_mul_f32 v112, v112, v5
    v_mul_f32 v113, v113, v5
    v_mul_f32 v114, v114, v5
    v_mul_f32 v115, v115, v5
    v_cvt_pk_bf16_f32 v48, v112, v113
    v_cvt_pk_bf16_f32 v49, v114, v115
    s_waitcnt lgkmcnt(4)
    v_add_f32 v132, v132, v148
    v_add_f32 v133, v133, v149
    v_add_f32 v134, v134, v150
    v_add_f32 v135, v135, v151
    s_waitcnt lgkmcnt(3)
    v_add_f32 v116, v116, v164
    v_add_f32 v117, v117, v165
    v_add_f32 v118, v118, v166
    v_add_f32 v119, v119, v167
    v_add_f32 v116, v116, v132
    v_add_f32 v117, v117, v133
    v_add_f32 v118, v118, v134
    v_add_f32 v119, v119, v135
    v_mul_f32 v116, v116, v5
    v_mul_f32 v117, v117, v5
    v_mul_f32 v118, v118, v5
    v_mul_f32 v119, v119, v5
    v_cvt_pk_bf16_f32 v50, v116, v117
    v_cvt_pk_bf16_f32 v51, v118, v119
    buffer_store_dwordx4 v[48:51], v8, s[40:43], s83 offen offset:0 sc1
    s_waitcnt lgkmcnt(1)
    v_add_f32 v136, v136, v152
    v_add_f32 v137, v137, v153
    v_add_f32 v138, v138, v154
    v_add_f32 v139, v139, v155
    s_waitcnt lgkmcnt(0)
    v_add_f32 v120, v120, v168
    v_add_f32 v121, v121, v169
    v_add_f32 v122, v122, v170
    v_add_f32 v123, v123, v171
    v_add_f32 v120, v120, v136
    v_add_f32 v121, v121, v137
    v_add_f32 v122, v122, v138
    v_add_f32 v123, v123, v139
    v_mul_f32 v120, v120, v5
    v_mul_f32 v121, v121, v5
    v_mul_f32 v122, v122, v5
    v_mul_f32 v123, v123, v5
    v_cvt_pk_bf16_f32 v52, v120, v121
    v_cvt_pk_bf16_f32 v53, v122, v123
    buffer_store_dwordx4 v[52:55], v8, s[40:43], s83 offen offset:1024 sc1
    s_cmp_eq_u32 s70, 7
    s_cbranch_scc1 L_fin
    v_lshrrev_b32 v57, 3, v1
    v_and_b32 v58, 7, v1
    v_mul_u32_u24 v56, 896, v57
    v_lshl_add_u32 v56, v58, 4, v56
    s_lshl_b32 s74, s68, 7
    s_lshl_b32 s75, s81, 6
    s_add_u32 s74, s74, s75
    s_lshl_b32 s75, s66, 3
    s_add_u32 s74, s74, s75
    s_mul_i32 s74, s74, 896
    s_lshl_b32 s76, s82, 7
    s_add_u32 s74, s74, s76
    v_add_u32 v56, s74, v56
    buffer_load_dwordx4 v[60:63], v56, s[28:31], 0 offen
    v_add_u32 v57, s75, v57
    v_mul_u32_u24 v57, 144, v57
    v_lshl_add_u32 v57, v58, 4, v57
    v_add_u32 v57, 65536, v57
    v_add_u32 v58, 49152, v57
L_final:
    s_barrier
    ds_read_b128 v[64:67], v57 offset:0
    ds_read_b128 v[68:71], v57 offset:24576
    ds_read_b128 v[72:75], v58 offset:0
    ds_read_b128 v[76:79], v58 offset:24576
    v_mov_b32 v6, 0x00003f80
    v_mov_b32 v7, 0x3f800000
    s_waitcnt vmcnt(0)
    v_lshlrev_b32 v8, 16, v60
    v_and_b32 v9, s86, v60
    v_lshlrev_b32 v10, 16, v61
    v_and_b32 v11, s86, v61
    v_lshlrev_b32 v12, 16, v62
    v_and_b32 v13, s86, v62
    v_lshlrev_b32 v14, 16, v63
    v_and_b32 v15, s86, v63
    s_waitcnt lgkmcnt(3)
    v_dot2c_f32_bf16 v8, v64, v6
    v_dot2c_f32_bf16 v9, v64, v7
    v_dot2c_f32_bf16 v10, v65, v6
    v_dot2c_f32_bf16 v11, v65, v7
    v_dot2c_f32_bf16 v12, v66, v6
    v_dot2c_f32_bf16 v13, v66, v7
    v_dot2c_f32_bf16 v14, v67, v6
    v_dot2c_f32_bf16 v15, v67, v7
    s_waitcnt lgkmcnt(2)
    v_dot2c_f32_bf16 v8, v68, v6
    v_dot2c_f32_bf16 v9, v68, v7
    v_dot2c_f32_bf16 v10, v69, v6
    v_dot2c_f32_bf16 v11, v69, v7
    v_dot2c_f32_bf16 v12, v70, v6
    v_dot2c_f32_bf16 v13, v70, v7
    v_dot2c_f32_bf16 v14, v71, v6
    v_dot2c_f32_bf16 v15, v71, v7
    s_waitcnt lgkmcnt(1)
    v_dot2c_f32_bf16 v8, v72, v6
    v_dot2c_f32_bf16 v9, v72, v7
    v_dot2c_f32_bf16 v10, v73, v6
    v_dot2c_f32_bf16 v11, v73, v7
    v_dot2c_f32_bf16 v12, v74, v6
    v_dot2c_f32_bf16 v13, v74, v7
    v_dot2c_f32_bf16 v14, v75, v6
    v_dot2c_f32_bf16 v15, v75, v7
    s_waitcnt lgkmcnt(0)
    v_dot2c_f32_bf16 v8, v76, v6
    v_dot2c_f32_bf16 v9, v76, v7
    v_dot2c_f32_bf16 v10, v77, v6
    v_dot2c_f32_bf16 v11, v77, v7
    v_dot2c_f32_bf16 v12, v78, v6
    v_dot2c_f32_bf16 v13, v78, v7
    v_dot2c_f32_bf16 v14, v79, v6
    v_dot2c_f32_bf16 v15, v79, v7
    v_cvt_pk_bf16_f32 v60, v8, v9
    v_cvt_pk_bf16_f32 v61, v10, v11
    v_cvt_pk_bf16_f32 v62, v12, v13
    v_cvt_pk_bf16_f32 v63, v14, v15
    buffer_store_dwordx4 v[60:63], v56, s[52:55], 0 offen
L_fin:
L_end:
    s_endpgm
L_G:
    s_and_b32 s71, s2, 1
    s_lshl3_add_u32 s69, s71, s70
    s_sub_u32 s72, s69, s71
    s_mov_b32 s86, 0xffff0000
    s_mov_b32 s94, 0
    s_mov_b32 s95, -1
    s_lshr_b32 s82, s70, 1
    s_lshl2_add_u32 s82, s71, s82
    s_and_b32 s81, s70, 1
    s_cmp_eq_u32 s70, 6
    s_cselect_b32 s82, 3, s82
    s_cselect_b32 s81, s71, s81
    s_mov_b32 s40, s26
    s_mov_b32 s41, s27
    s_mov_b32 s42, 10223616
    s_mov_b32 s43, 0x20000
    s_mov_b32 s52, s22
    s_mov_b32 s53, s23
    s_mov_b32 s54, 1835008
    s_mov_b32 s55, 0x20000
    s_mov_b32 s56, s24
    s_mov_b32 s57, s25
    s_mov_b32 s58, 256
    s_mov_b32 s59, 0x20000
    s_mov_b32 s60, s26
    s_mov_b32 s61, s27
    s_cmp_eq_u32 s70, 7
    s_cselect_b32 s62, 0, 10223616
    s_mov_b32 s63, 0x20000
    s_mul_i32 s92, s74, 112
    s_lshl3_add_u32 s92, s72, s92
    s_lshl_b32 s92, s92, 10
    s_add_u32 s92, s92, 2621440
    s_add_u32 s6, s92, 0
    s_add_u32 s7, s92, 1024
    s_add_u32 s14, s92, 2048
    s_add_u32 s15, s92, 3072
    s_add_u32 s16, s92, 4096
    s_add_u32 s17, s92, 5120
    s_add_u32 s18, s92, 6144
    s_add_u32 s19, s92, 7168
    v_and_b32 v8, 31, v1
    v_lshrrev_b32 v9, 5, v1
    v_bfe_u32 v10, v8, 1, 3
    v_xor_b32 v10, v10, v9
    v_lshlrev_b32 v10, 4, v10
    v_lshl_add_u32 v10, v8, 7, v10
    v_add_u32 v20, s91, v10
    v_xor_b32 v21, 32, v20
    v_xor_b32 v22, 64, v20
    v_xor_b32 v23, 96, v20
    v_mov_b32 v30, 0x3f803f80
    v_mov_b32 v14, 0
    v_mov_b32 v15, 0
    v_mov_b32 v16, 0
    v_mov_b32 v17, 0
    v_lshlrev_b32 v29, 4, v1
    s_waitcnt lgkmcnt(0)
    s_waitcnt vmcnt(8)
    ds_read_b128 v[128:131], v20 offset:0
    ds_read_b128 v[132:135], v21 offset:0
    ds_read_b128 v[136:139], v22 offset:0
    ds_read_b128 v[140:143], v23 offset:0
    s_add_u32 m0, s91, 12288
    s_add_u32 s75, s90, s76
    buffer_load_dwordx4 v4, s[28:31], s75 offen offset:0 lds
    buffer_load_dwordx4 v5, s[28:31], s75 offen offset:1024 lds
    buffer_load_dwordx4 v6, s[28:31], s75 offen offset:2048 lds
    buffer_load_dwordx4 v7, s[28:31], s75 offen offset:3072 lds
    s_add_u32 s76, s76, 128
    s_cmp_eq_u32 s76, 896
    s_cselect_b32 s76, 0, s76
    s_waitcnt vmcnt(8)
    ds_read_b128 v[144:147], v20 offset:4096
    ds_read_b128 v[148:151], v21 offset:4096
    ds_read_b128 v[152:155], v22 offset:4096
    ds_read_b128 v[156:159], v23 offset:4096
    s_add_u32 m0, s91, 16384
    s_add_u32 s75, s90, s76
    buffer_load_dwordx4 v4, s[28:31], s75 offen offset:0 lds
    buffer_load_dwordx4 v5, s[28:31], s75 offen offset:1024 lds
    buffer_load_dwordx4 v6, s[28:31], s75 offen offset:2048 lds
    buffer_load_dwordx4 v7, s[28:31], s75 offen offset:3072 lds
    s_add_u32 s76, s76, 128
    s_cmp_eq_u32 s76, 896
    s_cselect_b32 s76, 0, s76
    s_waitcnt lgkmcnt(4)
    v_dot2c_f32_bf16 v14, v128, v30
    v_dot2c_f32_bf16 v16, v128, v128
    v_dot2c_f32_bf16 v15, v129, v30
    v_dot2c_f32_bf16 v17, v129, v129
    v_dot2c_f32_bf16 v14, v130, v30
    v_dot2c_f32_bf16 v16, v130, v130
    v_dot2c_f32_bf16 v15, v131, v30
    v_dot2c_f32_bf16 v17, v131, v131
    v_dot2c_f32_bf16 v14, v132, v30
    v_dot2c_f32_bf16 v16, v132, v132
    v_dot2c_f32_bf16 v15, v133, v30
    v_dot2c_f32_bf16 v17, v133, v133
    v_dot2c_f32_bf16 v14, v134, v30
    v_dot2c_f32_bf16 v16, v134, v134
    v_dot2c_f32_bf16 v15, v135, v30
    v_dot2c_f32_bf16 v17, v135, v135
    v_dot2c_f32_bf16 v14, v136, v30
    v_dot2c_f32_bf16 v16, v136, v136
    v_dot2c_f32_bf16 v15, v137, v30
    v_dot2c_f32_bf16 v17, v137, v137
    v_dot2c_f32_bf16 v14, v138, v30
    v_dot2c_f32_bf16 v16, v138, v138
    v_dot2c_f32_bf16 v15, v139, v30
    v_dot2c_f32_bf16 v17, v139, v139
    v_dot2c_f32_bf16 v14, v140, v30
    v_dot2c_f32_bf16 v16, v140, v140
    v_dot2c_f32_bf16 v15, v141, v30
    v_dot2c_f32_bf16 v17, v141, v141
    v_dot2c_f32_bf16 v14, v142, v30
    v_dot2c_f32_bf16 v16, v142, v142
    v_dot2c_f32_bf16 v15, v143, v30
    v_dot2c_f32_bf16 v17, v143, v143
    s_waitcnt vmcnt(8)
    ds_read_b128 v[160:163], v20 offset:8192
    ds_read_b128 v[164:167], v21 offset:8192
    ds_read_b128 v[168:171], v22 offset:8192
    ds_read_b128 v[172:175], v23 offset:8192
    s_add_u32 m0, s91, 20480
    s_add_u32 s75, s90, s76
    buffer_load_dwordx4 v4, s[28:31], s75 offen offset:0 lds
    buffer_load_dwordx4 v5, s[28:31], s75 offen offset:1024 lds
    buffer_load_dwordx4 v6, s[28:31], s75 offen offset:2048 lds
    buffer_load_dwordx4 v7, s[28:31], s75 offen offset:3072 lds
    s_add_u32 s76, s76, 128
    s_cmp_eq_u32 s76, 896
    s_cselect_b32 s76, 0, s76
    s_waitcnt lgkmcnt(4)
    v_dot2c_f32_bf16 v14, v144, v30
    v_dot2c_f32_bf16 v16, v144, v144
    v_dot2c_f32_bf16 v15, v145, v30
    v_dot2c_f32_bf16 v17, v145, v145
    v_dot2c_f32_bf16 v14, v146, v30
    v_dot2c_f32_bf16 v16, v146, v146
    v_dot2c_f32_bf16 v15, v147, v30
    v_dot2c_f32_bf16 v17, v147, v147
    v_dot2c_f32_bf16 v14, v148, v30
    v_dot2c_f32_bf16 v16, v148, v148
    v_dot2c_f32_bf16 v15, v149, v30
    v_dot2c_f32_bf16 v17, v149, v149
    v_dot2c_f32_bf16 v14, v150, v30
    v_dot2c_f32_bf16 v16, v150, v150
    v_dot2c_f32_bf16 v15, v151, v30
    v_dot2c_f32_bf16 v17, v151, v151
    v_dot2c_f32_bf16 v14, v152, v30
    v_dot2c_f32_bf16 v16, v152, v152
    v_dot2c_f32_bf16 v15, v153, v30
    v_dot2c_f32_bf16 v17, v153, v153
    v_dot2c_f32_bf16 v14, v154, v30
    v_dot2c_f32_bf16 v16, v154, v154
    v_dot2c_f32_bf16 v15, v155, v30
    v_dot2c_f32_bf16 v17, v155, v155
    v_dot2c_f32_bf16 v14, v156, v30
    v_dot2c_f32_bf16 v16, v156, v156
    v_dot2c_f32_bf16 v15, v157, v30
    v_dot2c_f32_bf16 v17, v157, v157
    v_dot2c_f32_bf16 v14, v158, v30
    v_dot2c_f32_bf16 v16, v158, v158
    v_dot2c_f32_bf16 v15, v159, v30
    v_dot2c_f32_bf16 v17, v159, v159
    s_waitcnt vmcnt(8)
    ds_read_b128 v[176:179], v20 offset:12288
    ds_read_b128 v[180:183], v21 offset:12288
    ds_read_b128 v[184:187], v22 offset:12288
    ds_read_b128 v[188:191], v23 offset:12288
    s_add_u32 m0, s91, 24576
    s_add_u32 s75, s90, s76
    buffer_load_dwordx4 v4, s[28:31], s75 offen offset:0 lds
    buffer_load_dwordx4 v5, s[28:31], s75 offen offset:1024 lds
    buffer_load_dwordx4 v6, s[28:31], s75 offen offset:2048 lds
    buffer_load_dwordx4 v7, s[28:31], s75 offen offset:3072 lds
    s_barrier
    s_waitcnt lgkmcnt(4)
    v_dot2c_f32_bf16 v14, v160, v30
    v_dot2c_f32_bf16 v16, v160, v160
    v_dot2c_f32_bf16 v15, v161, v30
    v_dot2c_f32_bf16 v17, v161, v161
    v_dot2c_f32_bf16 v14, v162, v30
    v_dot2c_f32_bf16 v16, v162, v162
    v_dot2c_f32_bf16 v15, v163, v30
    v_dot2c_f32_bf16 v17, v163, v163
    v_dot2c_f32_bf16 v14, v164, v30
    v_dot2c_f32_bf16 v16, v164, v164
    v_dot2c_f32_bf16 v15, v165, v30
    v_dot2c_f32_bf16 v17, v165, v165
    v_dot2c_f32_bf16 v14, v166, v30
    v_dot2c_f32_bf16 v16, v166, v166
    v_dot2c_f32_bf16 v15, v167, v30
    v_dot2c_f32_bf16 v17, v167, v167
    v_dot2c_f32_bf16 v14, v168, v30
    v_dot2c_f32_bf16 v16, v168, v168
    v_dot2c_f32_bf16 v15, v169, v30
    v_dot2c_f32_bf16 v17, v169, v169
    v_dot2c_f32_bf16 v14, v170, v30
    v_dot2c_f32_bf16 v16, v170, v170
    v_dot2c_f32_bf16 v15, v171, v30
    v_dot2c_f32_bf16 v17, v171, v171
    v_dot2c_f32_bf16 v14, v172, v30
    v_dot2c_f32_bf16 v16, v172, v172
    v_dot2c_f32_bf16 v15, v173, v30
    v_dot2c_f32_bf16 v17, v173, v173
    v_dot2c_f32_bf16 v14, v174, v30
    v_dot2c_f32_bf16 v16, v174, v174
    v_dot2c_f32_bf16 v15, v175, v30
    v_dot2c_f32_bf16 v17, v175, v175
    s_waitcnt vmcnt(8)
    ds_read_b128 v[192:195], v20 offset:16384
    ds_read_b128 v[196:199], v21 offset:16384
    ds_read_b128 v[200:203], v22 offset:16384
    ds_read_b128 v[204:207], v23 offset:16384
    s_waitcnt lgkmcnt(4)
    v_dot2c_f32_bf16 v14, v176, v30
    v_dot2c_f32_bf16 v16, v176, v176
    v_dot2c_f32_bf16 v15, v177, v30
    v_dot2c_f32_bf16 v17, v177, v177
    v_dot2c_f32_bf16 v14, v178, v30
    v_dot2c_f32_bf16 v16, v178, v178
    v_dot2c_f32_bf16 v15, v179, v30
    v_dot2c_f32_bf16 v17, v179, v179
    v_dot2c_f32_bf16 v14, v180, v30
    v_dot2c_f32_bf16 v16, v180, v180
    v_dot2c_f32_bf16 v15, v181, v30
    v_dot2c_f32_bf16 v17, v181, v181
    v_dot2c_f32_bf16 v14, v182, v30
    v_dot2c_f32_bf16 v16, v182, v182
    v_dot2c_f32_bf16 v15, v183, v30
    v_dot2c_f32_bf16 v17, v183, v183
    v_dot2c_f32_bf16 v14, v184, v30
    v_dot2c_f32_bf16 v16, v184, v184
    v_dot2c_f32_bf16 v15, v185, v30
    v_dot2c_f32_bf16 v17, v185, v185
    v_dot2c_f32_bf16 v14, v186, v30
    v_dot2c_f32_bf16 v16, v186, v186
    v_dot2c_f32_bf16 v15, v187, v30
    v_dot2c_f32_bf16 v17, v187, v187
    v_dot2c_f32_bf16 v14, v188, v30
    v_dot2c_f32_bf16 v16, v188, v188
    v_dot2c_f32_bf16 v15, v189, v30
    v_dot2c_f32_bf16 v17, v189, v189
    v_dot2c_f32_bf16 v14, v190, v30
    v_dot2c_f32_bf16 v16, v190, v190
    v_dot2c_f32_bf16 v15, v191, v30
    v_dot2c_f32_bf16 v17, v191, v191
    s_waitcnt vmcnt(4)
    ds_read_b128 v[208:211], v20 offset:20480
    ds_read_b128 v[212:215], v21 offset:20480
    ds_read_b128 v[216:219], v22 offset:20480
    ds_read_b128 v[220:223], v23 offset:20480
    s_waitcnt lgkmcnt(4)
    v_dot2c_f32_bf16 v14, v192, v30
    v_dot2c_f32_bf16 v16, v192, v192
    v_dot2c_f32_bf16 v15, v193, v30
    v_dot2c_f32_bf16 v17, v193, v193
    v_dot2c_f32_bf16 v14, v194, v30
    v_dot2c_f32_bf16 v16, v194, v194
    v_dot2c_f32_bf16 v15, v195, v30
    v_dot2c_f32_bf16 v17, v195, v195
    v_dot2c_f32_bf16 v14, v196, v30
    v_dot2c_f32_bf16 v16, v196, v196
    v_dot2c_f32_bf16 v15, v197, v30
    v_dot2c_f32_bf16 v17, v197, v197
    v_dot2c_f32_bf16 v14, v198, v30
    v_dot2c_f32_bf16 v16, v198, v198
    v_dot2c_f32_bf16 v15, v199, v30
    v_dot2c_f32_bf16 v17, v199, v199
    v_dot2c_f32_bf16 v14, v200, v30
    v_dot2c_f32_bf16 v16, v200, v200
    v_dot2c_f32_bf16 v15, v201, v30
    v_dot2c_f32_bf16 v17, v201, v201
    v_dot2c_f32_bf16 v14, v202, v30
    v_dot2c_f32_bf16 v16, v202, v202
    v_dot2c_f32_bf16 v15, v203, v30
    v_dot2c_f32_bf16 v17, v203, v203
    v_dot2c_f32_bf16 v14, v204, v30
    v_dot2c_f32_bf16 v16, v204, v204
    v_dot2c_f32_bf16 v15, v205, v30
    v_dot2c_f32_bf16 v17, v205, v205
    v_dot2c_f32_bf16 v14, v206, v30
    v_dot2c_f32_bf16 v16, v206, v206
    v_dot2c_f32_bf16 v15, v207, v30
    v_dot2c_f32_bf16 v17, v207, v207
    s_waitcnt vmcnt(0)
    ds_read_b128 v[224:227], v20 offset:24576
    ds_read_b128 v[228:231], v21 offset:24576
    ds_read_b128 v[232:235], v22 offset:24576
    ds_read_b128 v[236:239], v23 offset:24576
    s_waitcnt lgkmcnt(4)
    v_dot2c_f32_bf16 v14, v208, v30
    v_dot2c_f32_bf16 v16, v208, v208
    v_dot2c_f32_bf16 v15, v209, v30
    v_dot2c_f32_bf16 v17, v209, v209
    v_dot2c_f32_bf16 v14, v210, v30
    v_dot2c_f32_bf16 v16, v210, v210
    v_dot2c_f32_bf16 v15, v211, v30
    v_dot2c_f32_bf16 v17, v211, v211
    v_dot2c_f32_bf16 v14, v212, v30
    v_dot2c_f32_bf16 v16, v212, v212
    v_dot2c_f32_bf16 v15, v213, v30
    v_dot2c_f32_bf16 v17, v213, v213
    v_dot2c_f32_bf16 v14, v214, v30
    v_dot2c_f32_bf16 v16, v214, v214
    v_dot2c_f32_bf16 v15, v215, v30
    v_dot2c_f32_bf16 v17, v215, v215
    v_dot2c_f32_bf16 v14, v216, v30
    v_dot2c_f32_bf16 v16, v216, v216
    v_dot2c_f32_bf16 v15, v217, v30
    v_dot2c_f32_bf16 v17, v217, v217
    v_dot2c_f32_bf16 v14, v218, v30
    v_dot2c_f32_bf16 v16, v218, v218
    v_dot2c_f32_bf16 v15, v219, v30
    v_dot2c_f32_bf16 v17, v219, v219
    v_dot2c_f32_bf16 v14, v220, v30
    v_dot2c_f32_bf16 v16, v220, v220
    v_dot2c_f32_bf16 v15, v221, v30
    v_dot2c_f32_bf16 v17, v221, v221
    v_dot2c_f32_bf16 v14, v222, v30
    v_dot2c_f32_bf16 v16, v222, v222
    v_dot2c_f32_bf16 v15, v223, v30
    v_dot2c_f32_bf16 v17, v223, v223
    v_bfe_u32 v8, v1, 4, 1
    v_bfe_u32 v10, v1, 2, 2
    v_and_b32 v11, 3, v1
    v_lshlrev_b32 v11, 3, v11
    v_lshl_add_u32 v12, v9, 3, v10
    v_lshlrev_b32 v12, 6, v12
    v_lshl_add_u32 v12, v8, 5, v12
    v_add_u32 v28, v12, v11
    v_lshrrev_b32 v12, 1, v10
    v_lshl_or_b32 v12, v8, 1, v12
    v_lshl_add_u32 v12, v12, 5, v11
    v_lshl_add_u32 v12, v10, 7, v12
    v_lshl_add_u32 v12, v8, 10, v12
    v_lshl_add_u32 v12, v9, 11, v12
    s_waitcnt lgkmcnt(0)
    s_barrier
    v_add_u32 v2, 114688, v12
    v_xor_b32 v3, 32, v2
    v_xor_b32 v4, 64, v2
    v_xor_b32 v5, 96, v2
    v_dot2c_f32_bf16 v14, v224, v30
    v_dot2c_f32_bf16 v16, v224, v224
    v_dot2c_f32_bf16 v15, v225, v30
    v_dot2c_f32_bf16 v17, v225, v225
    v_dot2c_f32_bf16 v14, v226, v30
    v_dot2c_f32_bf16 v16, v226, v226
    v_dot2c_f32_bf16 v15, v227, v30
    v_dot2c_f32_bf16 v17, v227, v227
    v_dot2c_f32_bf16 v14, v228, v30
    v_dot2c_f32_bf16 v16, v228, v228
    v_dot2c_f32_bf16 v15, v229, v30
    v_dot2c_f32_bf16 v17, v229, v229
    v_dot2c_f32_bf16 v14, v230, v30
    v_dot2c_f32_bf16 v16, v230, v230
    v_dot2c_f32_bf16 v15, v231, v30
    v_dot2c_f32_bf16 v17, v231, v231
    v_dot2c_f32_bf16 v14, v232, v30
    v_dot2c_f32_bf16 v16, v232, v232
    v_dot2c_f32_bf16 v15, v233, v30
    v_dot2c_f32_bf16 v17, v233, v233
    v_dot2c_f32_bf16 v14, v234, v30
    v_dot2c_f32_bf16 v16, v234, v234
    v_dot2c_f32_bf16 v15, v235, v30
    v_dot2c_f32_bf16 v17, v235, v235
    v_dot2c_f32_bf16 v14, v236, v30
    v_dot2c_f32_bf16 v16, v236, v236
    v_dot2c_f32_bf16 v15, v237, v30
    v_dot2c_f32_bf16 v17, v237, v237
    v_dot2c_f32_bf16 v14, v238, v30
    v_dot2c_f32_bf16 v16, v238, v238
    v_dot2c_f32_bf16 v15, v239, v30
    v_dot2c_f32_bf16 v17, v239, v239
    s_nop 2
    v_add_f32 v8, v14, v15
    v_add_f32 v9, v16, v17
    v_mov_b32 v14, v8
    v_mov_b32 v15, v9
    s_nop 0
    v_permlane32_swap_b32 v8, v14
    v_permlane32_swap_b32 v9, v15
    v_add_f32 v8, v8, v14
    v_add_f32 v9, v9, v15
    v_mul_f32 v8, 0x3b124925, v8
    v_mul_f32 v9, 0x3b124925, v9
    v_fma_f32 v9, -v8, v8, v9
    v_max_f32 v9, 0, v9
    v_add_f32 v9, 0x3727c5ac, v9
    v_rsq_f32 v11, v9
    s_nop 0
    v_mul_f32 v10, 0xbfb8aa3b, v11
    s_cmp_eq_u32 s70, 7
    s_cbranch_scc1 L_G_light
    v_add_u32 v28, 16384, v28
    v_mov_b32 v6, 0x00003f80
    v_mov_b32 v7, 0x3f800000
    v_sub_f32 v12, 0, v8
    v_dot2_f32_bf16 v14, v128, v6, v12
    v_dot2_f32_bf16 v15, v128, v7, v12
    v_dot2_f32_bf16 v16, v129, v6, v12
    v_dot2_f32_bf16 v17, v129, v7, v12
    v_dot2_f32_bf16 v18, v130, v6, v12
    v_dot2_f32_bf16 v19, v130, v7, v12
    v_cvt_pk_bf16_f32 v128, v14, v15
    v_dot2_f32_bf16 v14, v131, v6, v12
    v_dot2_f32_bf16 v15, v131, v7, v12
    v_cvt_pk_bf16_f32 v129, v16, v17
    v_dot2_f32_bf16 v16, v132, v6, v12
    v_dot2_f32_bf16 v17, v132, v7, v12
    v_cvt_pk_bf16_f32 v130, v18, v19
    v_dot2_f32_bf16 v18, v133, v6, v12
    v_dot2_f32_bf16 v19, v133, v7, v12
    v_cvt_pk_bf16_f32 v131, v14, v15
    v_dot2_f32_bf16 v14, v134, v6, v12
    v_dot2_f32_bf16 v15, v134, v7, v12
    v_cvt_pk_bf16_f32 v132, v16, v17
    v_dot2_f32_bf16 v16, v135, v6, v12
    v_dot2_f32_bf16 v17, v135, v7, v12
    v_cvt_pk_bf16_f32 v133, v18, v19
    s_nop 1
    v_cvt_pk_bf16_f32 v134, v14, v15
    s_nop 1
    v_cvt_pk_bf16_f32 v135, v16, v17
    s_barrier
    ds_read_b64_tr_b16 v[240:241], v2 offset:0
    ds_read_b64_tr_b16 v[242:243], v2 offset:512
    ds_read_b64_tr_b16 v[244:245], v3 offset:0
    ds_read_b64_tr_b16 v[246:247], v3 offset:512
    ds_read_b64_tr_b16 v[248:249], v4 offset:0
    ds_read_b64_tr_b16 v[250:251], v4 offset:512
    ds_read_b64_tr_b16 v[252:253], v5 offset:0
    ds_read_b64_tr_b16 v[254:255], v5 offset:512
    s_waitcnt lgkmcnt(4)
    v_mfma_f32_32x32x16_bf16 v[64:79], v[240:243], v[128:131], 0
    ds_read_b64_tr_b16 v[240:241], v2 offset:4096
    ds_read_b64_tr_b16 v[242:243], v2 offset:4608
    v_lshlrev_b32 v14, 16, v136
    v_and_b32 v15, s86, v136
    v_sub_f32 v14, v14, v8
    v_sub_f32 v15, v15, v8
    v_cvt_pk_bf16_f32 v136, v14, v15
    v_mfma_f32_32x32x16_bf16 v[80:95], v[244:247], v[128:131], 0
    s_waitcnt lgkmcnt(2)
    ds_read_b64_tr_b16 v[244:245], v3 offset:4096
    ds_read_b64_tr_b16 v[246:247], v3 offset:4608
    v_lshlrev_b32 v16, 16, v137
    v_and_b32 v17, s86, v137
    v_sub_f32 v16, v16, v8
    v_sub_f32 v17, v17, v8
    v_cvt_pk_bf16_f32 v137, v16, v17
    v_mfma_f32_32x32x16_bf16 v[96:111], v[248:251], v[128:131], 0
    ds_read_b64_tr_b16 v[248:249], v4 offset:4096
    ds_read_b64_tr_b16 v[250:251], v4 offset:4608
    v_lshlrev_b32 v14, 16, v138
    v_and_b32 v15, s86, v138
    v_sub_f32 v14, v14, v8
    v_sub_f32 v15, v15, v8
    v_cvt_pk_bf16_f32 v138, v14, v15
    v_mfma_f32_32x32x16_bf16 v[112:127], v[252:255], v[128:131], 0
    s_waitcnt lgkmcnt(2)
    ds_read_b64_tr_b16 v[252:253], v5 offset:4096
    ds_read_b64_tr_b16 v[254:255], v5 offset:4608
    v_lshlrev_b32 v16, 16, v139
    v_and_b32 v17, s86, v139
    v_sub_f32 v16, v16, v8
    v_sub_f32 v17, v17, v8
    v_cvt_pk_bf16_f32 v139, v16, v17
    v_mfma_f32_32x32x16_bf16 v[64:79], v[240:243], v[132:135], v[64:79]
    ds_read_b64_tr_b16 v[240:241], v2 offset:8192
    ds_read_b64_tr_b16 v[242:243], v2 offset:8704
    v_lshlrev_b32 v14, 16, v140
    v_and_b32 v15, s86, v140
    v_sub_f32 v14, v14, v8
    v_sub_f32 v15, v15, v8
    v_cvt_pk_bf16_f32 v140, v14, v15
    v_mfma_f32_32x32x16_bf16 v[80:95], v[244:247], v[132:135], v[80:95]
    s_waitcnt lgkmcnt(2)
    ds_read_b64_tr_b16 v[244:245], v3 offset:8192
    ds_read_b64_tr_b16 v[246:247], v3 offset:8704
    v_lshlrev_b32 v16, 16, v141
    v_and_b32 v17, s86, v141
    v_sub_f32 v16, v16, v8
    v_sub_f32 v17, v17, v8
    v_cvt_pk_bf16_f32 v141, v16, v17
    v_mfma_f32_32x32x16_bf16 v[96:111], v[248:251], v[132:135], v[96:111]
    ds_read_b64_tr_b16 v[248:249], v4 offset:8192
    ds_read_b64_tr_b16 v[250:251], v4 offset:8704
    v_lshlrev_b32 v14, 16, v142
    v_and_b32 v15, s86, v142
    v_sub_f32 v14, v14, v8
    v_sub_f32 v15, v15, v8
    v_cvt_pk_bf16_f32 v142, v14, v15
    v_mfma_f32_32x32x16_bf16 v[112:127], v[252:255], v[132:135], v[112:127]
    s_waitcnt lgkmcnt(2)
    ds_read_b64_tr_b16 v[252:253], v5 offset:8192
    ds_read_b64_tr_b16 v[254:255], v5 offset:8704
    v_lshlrev_b32 v16, 16, v143
    v_and_b32 v17, s86, v143
    v_sub_f32 v16, v16, v8
    v_sub_f32 v17, v17, v8
    v_cvt_pk_bf16_f32 v143, v16, v17
    v_mfma_f32_32x32x16_bf16 v[64:79], v[240:243], v[136:139], v[64:79]
    ds_read_b64_tr_b16 v[240:241], v2 offset:12288
    ds_read_b64_tr_b16 v[242:243], v2 offset:12800
    v_lshlrev_b32 v14, 16, v144
    v_and_b32 v15, s86, v144
    v_sub_f32 v14, v14, v8
    v_sub_f32 v15, v15, v8
    v_cvt_pk_bf16_f32 v144, v14, v15
    v_mfma_f32_32x32x16_bf16 v[80:95], v[244:247], v[136:139], v[80:95]
    s_waitcnt lgkmcnt(2)
    ds_read_b64_tr_b16 v[244:245], v3 offset:12288
    ds_read_b64_tr_b16 v[246:247], v3 offset:12800
    v_lshlrev_b32 v16, 16, v145
    v_and_b32 v17, s86, v145
    v_sub_f32 v16, v16, v8
    v_sub_f32 v17, v17, v8
    v_cvt_pk_bf16_f32 v145, v16, v17
    v_mfma_f32_32x32x16_bf16 v[96:111], v[248:251], v[136:139], v[96:111]
    ds_read_b64_tr_b16 v[248:249], v4 offset:12288
    ds_read_b64_tr_b16 v[250:251], v4 offset:12800
    v_lshlrev_b32 v14, 16, v146
    v_and_b32 v15, s86, v146
    v_sub_f32 v14, v14, v8
    v_sub_f32 v15, v15, v8
    v_cvt_pk_bf16_f32 v146, v14, v15
    v_mfma_f32_32x32x16_bf16 v[112:127], v[252:255], v[136:139], v[112:127]
    s_waitcnt lgkmcnt(2)
    ds_read_b64_tr_b16 v[252:253], v5 offset:12288
    ds_read_b64_tr_b16 v[254:255], v5 offset:12800
    v_lshlrev_b32 v16, 16, v147
    v_and_b32 v17, s86, v147
    v_sub_f32 v16, v16, v8
    v_sub_f32 v17, v17, v8
    v_cvt_pk_bf16_f32 v147, v16, v17
    v_mfma_f32_32x32x16_bf16 v[64:79], v[240:243], v[140:143], v[64:79]
    s_barrier
    ds_read_b64_tr_b16 v[240:241], v2 offset:16384
    ds_read_b64_tr_b16 v[242:243], v2 offset:16896
    v_lshlrev_b32 v14, 16, v148
    v_and_b32 v15, s86, v148
    v_sub_f32 v14, v14, v8
    v_sub_f32 v15, v15, v8
    v_cvt_pk_bf16_f32 v148, v14, v15
    v_mfma_f32_32x32x16_bf16 v[80:95], v[244:247], v[140:143], v[80:95]
    s_waitcnt lgkmcnt(2)
    ds_read_b64_tr_b16 v[244:245], v3 offset:16384
    ds_read_b64_tr_b16 v[246:247], v3 offset:16896
    v_lshlrev_b32 v16, 16, v149
    v_and_b32 v17, s86, v149
    v_sub_f32 v16, v16, v8
    v_sub_f32 v17, v17, v8
    v_cvt_pk_bf16_f32 v149, v16, v17
    v_mfma_f32_32x32x16_bf16 v[96:111], v[248:251], v[140:143], v[96:111]
    ds_read_b64_tr_b16 v[248:249], v4 offset:16384
    ds_read_b64_tr_b16 v[250:251], v4 offset:16896
    v_lshlrev_b32 v14, 16, v150
    v_and_b32 v15, s86, v150
    v_sub_f32 v14, v14, v8
    v_sub_f32 v15, v15, v8
    v_cvt_pk_bf16_f32 v150, v14, v15
    v_mfma_f32_32x32x16_bf16 v[112:127], v[252:255], v[140:143], v[112:127]
    s_waitcnt lgkmcnt(2)
    ds_read_b64_tr_b16 v[252:253], v5 offset:16384
    ds_read_b64_tr_b16 v[254:255], v5 offset:16896
    v_lshlrev_b32 v16, 16, v151
    v_and_b32 v17, s86, v151
    v_sub_f32 v16, v16, v8
    v_sub_f32 v17, v17, v8
    v_cvt_pk_bf16_f32 v151, v16, v17
    v_mfma_f32_32x32x16_bf16 v[64:79], v[240:243], v[144:147], v[64:79]
    ds_read_b64_tr_b16 v[240:241], v2 offset:20480
    ds_read_b64_tr_b16 v[242:243], v2 offset:20992
    v_lshlrev_b32 v14, 16, v152
    v_and_b32 v15, s86, v152
    v_sub_f32 v14, v14, v8
    v_sub_f32 v15, v15, v8
    v_cvt_pk_bf16_f32 v152, v14, v15
    v_mfma_f32_32x32x16_bf16 v[80:95], v[244:247], v[144:147], v[80:95]
    s_waitcnt lgkmcnt(2)
    ds_read_b64_tr_b16 v[244:245], v3 offset:20480
    ds_read_b64_tr_b16 v[246:247], v3 offset:20992
    v_lshlrev_b32 v16, 16, v153
    v_and_b32 v17, s86, v153
    v_sub_f32 v16, v16, v8
    v_sub_f32 v17, v17, v8
    v_cvt_pk_bf16_f32 v153, v16, v17
    v_mfma_f32_32x32x16_bf16 v[96:111], v[248:251], v[144:147], v[96:111]
    ds_read_b64_tr_b16 v[248:249], v4 offset:20480
    ds_read_b64_tr_b16 v[250:251], v4 offset:20992
    v_lshlrev_b32 v14, 16, v154
    v_and_b32 v15, s86, v154
    v_sub_f32 v14, v14, v8
    v_sub_f32 v15, v15, v8
    v_cvt_pk_bf16_f32 v154, v14, v15
    v_mfma_f32_32x32x16_bf16 v[112:127], v[252:255], v[144:147], v[112:127]
    s_waitcnt lgkmcnt(2)
    ds_read_b64_tr_b16 v[252:253], v5 offset:20480
    ds_read_b64_tr_b16 v[254:255], v5 offset:20992
    v_lshlrev_b32 v16, 16, v155
    v_and_b32 v17, s86, v155
    v_sub_f32 v16, v16, v8
    v_sub_f32 v17, v17, v8
    v_cvt_pk_bf16_f32 v155, v16, v17
    v_mfma_f32_32x32x16_bf16 v[64:79], v[240:243], v[148:151], v[64:79]
    ds_read_b64_tr_b16 v[240:241], v2 offset:24576
    ds_read_b64_tr_b16 v[242:243], v2 offset:25088
    v_lshlrev_b32 v14, 16, v156
    v_and_b32 v15, s86, v156
    v_sub_f32 v14, v14, v8
    v_sub_f32 v15, v15, v8
    v_cvt_pk_bf16_f32 v156, v14, v15
    v_mfma_f32_32x32x16_bf16 v[80:95], v[244:247], v[148:151], v[80:95]
    s_waitcnt lgkmcnt(2)
    ds_read_b64_tr_b16 v[244:245], v3 offset:24576
    ds_read_b64_tr_b16 v[246:247], v3 offset:25088
    v_lshlrev_b32 v16, 16, v157
    v_and_b32 v17, s86, v157
    v_sub_f32 v16, v16, v8
    v_sub_f32 v17, v17, v8
    v_cvt_pk_bf16_f32 v157, v16, v17
    v_mfma_f32_32x32x16_bf16 v[96:111], v[248:251], v[148:151], v[96:111]
    ds_read_b64_tr_b16 v[248:249], v4 offset:24576
    ds_read_b64_tr_b16 v[250:251], v4 offset:25088
    v_lshlrev_b32 v14, 16, v158
    v_and_b32 v15, s86, v158
    v_sub_f32 v14, v14, v8
    v_sub_f32 v15, v15, v8
    v_cvt_pk_bf16_f32 v158, v14, v15
    v_mfma_f32_32x32x16_bf16 v[112:127], v[252:255], v[148:151], v[112:127]
    s_waitcnt lgkmcnt(2)
    ds_read_b64_tr_b16 v[252:253], v5 offset:24576
    ds_read_b64_tr_b16 v[254:255], v5 offset:25088
    v_lshlrev_b32 v16, 16, v159
    v_and_b32 v17, s86, v159
    v_sub_f32 v16, v16, v8
    v_sub_f32 v17, v17, v8
    v_cvt_pk_bf16_f32 v159, v16, v17
    v_mfma_f32_32x32x16_bf16 v[64:79], v[240:243], v[152:155], v[64:79]
    ds_read_b64_tr_b16 v[240:241], v2 offset:28672
    ds_read_b64_tr_b16 v[242:243], v2 offset:29184
    v_lshlrev_b32 v14, 16, v160
    v_and_b32 v15, s86, v160
    v_sub_f32 v14, v14, v8
    v_sub_f32 v15, v15, v8
    v_cvt_pk_bf16_f32 v160, v14, v15
    v_mfma_f32_32x32x16_bf16 v[80:95], v[244:247], v[152:155], v[80:95]
    s_waitcnt lgkmcnt(2)
    ds_read_b64_tr_b16 v[244:245], v3 offset:28672
    ds_read_b64_tr_b16 v[246:247], v3 offset:29184
    v_lshlrev_b32 v16, 16, v161
    v_and_b32 v17, s86, v161
    v_sub_f32 v16, v16, v8
    v_sub_f32 v17, v17, v8
    v_cvt_pk_bf16_f32 v161, v16, v17
    v_mfma_f32_32x32x16_bf16 v[96:111], v[248:251], v[152:155], v[96:111]
    ds_read_b64_tr_b16 v[248:249], v4 offset:28672
    ds_read_b64_tr_b16 v[250:251], v4 offset:29184
    v_lshlrev_b32 v14, 16, v162
    v_and_b32 v15, s86, v162
    v_sub_f32 v14, v14, v8
    v_sub_f32 v15, v15, v8
    v_cvt_pk_bf16_f32 v162, v14, v15
    v_mfma_f32_32x32x16_bf16 v[112:127], v[252:255], v[152:155], v[112:127]
    s_waitcnt lgkmcnt(2)
    ds_read_b64_tr_b16 v[252:253], v5 offset:28672
    ds_read_b64_tr_b16 v[254:255], v5 offset:29184
    v_lshlrev_b32 v16, 16, v163
    v_and_b32 v17, s86, v163
    v_sub_f32 v16, v16, v8
    v_sub_f32 v17, v17, v8
    v_cvt_pk_bf16_f32 v163, v16, v17
    v_mfma_f32_32x32x16_bf16 v[64:79], v[240:243], v[156:159], v[64:79]
    ds_read_b64_tr_b16 v[240:241], v2 offset:32768
    ds_read_b64_tr_b16 v[242:243], v2 offset:33280
    v_lshlrev_b32 v14, 16, v164
    v_and_b32 v15, s86, v164
    v_sub_f32 v14, v14, v8
    v_sub_f32 v15, v15, v8
    v_cvt_pk_bf16_f32 v164, v14, v15
    v_mfma_f32_32x32x16_bf16 v[80:95], v[244:247], v[156:159], v[80:95]
    s_waitcnt lgkmcnt(2)
    ds_read_b64_tr_b16 v[244:245], v3 offset:32768
    ds_read_b64_tr_b16 v[246:247], v3 offset:33280
    v_lshlrev_b32 v16, 16, v165
    v_and_b32 v17, s86, v165
    v_sub_f32 v16, v16, v8
    v_sub_f32 v17, v17, v8
    v_cvt_pk_bf16_f32 v165, v16, v17
    v_mfma_f32_32x32x16_bf16 v[96:111], v[248:251], v[156:159], v[96:111]
    ds_read_b64_tr_b16 v[248:249], v4 offset:32768
    ds_read_b64_tr_b16 v[250:251], v4 offset:33280
    v_lshlrev_b32 v14, 16, v166
    v_and_b32 v15, s86, v166
    v_sub_f32 v14, v14, v8
    v_sub_f32 v15, v15, v8
    v_cvt_pk_bf16_f32 v166, v14, v15
    v_mfma_f32_32x32x16_bf16 v[112:127], v[252:255], v[156:159], v[112:127]
    s_waitcnt lgkmcnt(2)
    ds_read_b64_tr_b16 v[252:253], v5 offset:32768
    ds_read_b64_tr_b16 v[254:255], v5 offset:33280
    v_lshlrev_b32 v16, 16, v167
    v_and_b32 v17, s86, v167
    v_sub_f32 v16, v16, v8
    v_sub_f32 v17, v17, v8
    v_cvt_pk_bf16_f32 v167, v16, v17
    v_mfma_f32_32x32x16_bf16 v[64:79], v[240:243], v[160:163], v[64:79]
    ds_read_b64_tr_b16 v[240:241], v2 offset:36864
    ds_read_b64_tr_b16 v[242:243], v2 offset:37376
    v_lshlrev_b32 v14, 16, v168
    v_and_b32 v15, s86, v168
    v_sub_f32 v14, v14, v8
    v_sub_f32 v15, v15, v8
    v_cvt_pk_bf16_f32 v168, v14, v15
    v_mfma_f32_32x32x16_bf16 v[80:95], v[244:247], v[160:163], v[80:95]
    s_waitcnt lgkmcnt(2)
    ds_read_b64_tr_b16 v[244:245], v3 offset:36864
    ds_read_b64_tr_b16 v[246:247], v3 offset:37376
    v_lshlrev_b32 v16, 16, v169
    v_and_b32 v17, s86, v169
    v_sub_f32 v16, v16, v8
    v_sub_f32 v17, v17, v8
    v_cvt_pk_bf16_f32 v169, v16, v17
    v_mfma_f32_32x32x16_bf16 v[96:111], v[248:251], v[160:163], v[96:111]
    ds_read_b64_tr_b16 v[248:249], v4 offset:36864
    ds_read_b64_tr_b16 v[250:251], v4 offset:37376
    v_lshlrev_b32 v14, 16, v170
    v_and_b32 v15, s86, v170
    v_sub_f32 v14, v14, v8
    v_sub_f32 v15, v15, v8
    v_cvt_pk_bf16_f32 v170, v14, v15
    v_mfma_f32_32x32x16_bf16 v[112:127], v[252:255], v[160:163], v[112:127]
    s_waitcnt lgkmcnt(2)
    ds_read_b64_tr_b16 v[252:253], v5 offset:36864
    ds_read_b64_tr_b16 v[254:255], v5 offset:37376
    v_lshlrev_b32 v16, 16, v171
    v_and_b32 v17, s86, v171
    v_sub_f32 v16, v16, v8
    v_sub_f32 v17, v17, v8
    v_cvt_pk_bf16_f32 v171, v16, v17
    v_mfma_f32_32x32x16_bf16 v[64:79], v[240:243], v[164:167], v[64:79]
    ds_read_b64_tr_b16 v[240:241], v2 offset:40960
    ds_read_b64_tr_b16 v[242:243], v2 offset:41472
    v_lshlrev_b32 v14, 16, v172
    v_and_b32 v15, s86, v172
    v_sub_f32 v14, v14, v8
    v_sub_f32 v15, v15, v8
    v_cvt_pk_bf16_f32 v172, v14, v15
    v_mfma_f32_32x32x16_bf16 v[80:95], v[244:247], v[164:167], v[80:95]
    s_waitcnt lgkmcnt(2)
    ds_read_b64_tr_b16 v[244:245], v3 offset:40960
    ds_read_b64_tr_b16 v[246:247], v3 offset:41472
    v_lshlrev_b32 v16, 16, v173
    v_and_b32 v17, s86, v173
    v_sub_f32 v16, v16, v8
    v_sub_f32 v17, v17, v8
    v_cvt_pk_bf16_f32 v173, v16, v17
    v_mfma_f32_32x32x16_bf16 v[96:111], v[248:251], v[164:167], v[96:111]
    ds_read_b64_tr_b16 v[248:249], v4 offset:40960
    ds_read_b64_tr_b16 v[250:251], v4 offset:41472
    v_lshlrev_b32 v14, 16, v174
    v_and_b32 v15, s86, v174
    v_sub_f32 v14, v14, v8
    v_sub_f32 v15, v15, v8
    v_cvt_pk_bf16_f32 v174, v14, v15
    v_mfma_f32_32x32x16_bf16 v[112:127], v[252:255], v[164:167], v[112:127]
    s_waitcnt lgkmcnt(2)
    ds_read_b64_tr_b16 v[252:253], v5 offset:40960
    ds_read_b64_tr_b16 v[254:255], v5 offset:41472
    v_lshlrev_b32 v16, 16, v175
    v_and_b32 v17, s86, v175
    v_sub_f32 v16, v16, v8
    v_sub_f32 v17, v17, v8
    v_cvt_pk_bf16_f32 v175, v16, v17
    v_mfma_f32_32x32x16_bf16 v[64:79], v[240:243], v[168:171], v[64:79]
    ds_read_b64_tr_b16 v[240:241], v2 offset:45056
    ds_read_b64_tr_b16 v[242:243], v2 offset:45568
    v_lshlrev_b32 v14, 16, v176
    v_and_b32 v15, s86, v176
    v_sub_f32 v14, v14, v8
    v_sub_f32 v15, v15, v8
    v_cvt_pk_bf16_f32 v176, v14, v15
    v_mfma_f32_32x32x16_bf16 v[80:95], v[244:247], v[168:171], v[80:95]
    s_waitcnt lgkmcnt(2)
    ds_read_b64_tr_b16 v[244:245], v3 offset:45056
    ds_read_b64_tr_b16 v[246:247], v3 offset:45568
    v_lshlrev_b32 v16, 16, v177
    v_and_b32 v17, s86, v177
    v_sub_f32 v16, v16, v8
    v_sub_f32 v17, v17, v8
    v_cvt_pk_bf16_f32 v177, v16, v17
    v_mfma_f32_32x32x16_bf16 v[96:111], v[248:251], v[168:171], v[96:111]
    ds_read_b64_tr_b16 v[248:249], v4 offset:45056
    ds_read_b64_tr_b16 v[250:251], v4 offset:45568
    v_lshlrev_b32 v14, 16, v178
    v_and_b32 v15, s86, v178
    v_sub_f32 v14, v14, v8
    v_sub_f32 v15, v15, v8
    v_cvt_pk_bf16_f32 v178, v14, v15
    v_mfma_f32_32x32x16_bf16 v[112:127], v[252:255], v[168:171], v[112:127]
    s_waitcnt lgkmcnt(2)
    ds_read_b64_tr_b16 v[252:253], v5 offset:45056
    ds_read_b64_tr_b16 v[254:255], v5 offset:45568
    v_lshlrev_b32 v16, 16, v179
    v_and_b32 v17, s86, v179
    v_sub_f32 v16, v16, v8
    v_sub_f32 v17, v17, v8
    v_add_u32 v2, 0xfffe4000, v2
    v_mfma_f32_32x32x16_bf16 v[64:79], v[240:243], v[172:175], v[64:79]
    s_barrier
    ds_read_b64_tr_b16 v[240:241], v2 offset:0
    ds_read_b64_tr_b16 v[242:243], v2 offset:512
    v_cvt_pk_bf16_f32 v179, v16, v17
    v_lshlrev_b32 v14, 16, v180
    v_and_b32 v15, s86, v180
    v_sub_f32 v14, v14, v8
    v_add_u32 v3, 0xfffe4000, v3
    v_mfma_f32_32x32x16_bf16 v[80:95], v[244:247], v[172:175], v[80:95]
    s_waitcnt lgkmcnt(2)
    ds_read_b64_tr_b16 v[244:245], v3 offset:0
    ds_read_b64_tr_b16 v[246:247], v3 offset:512
    v_sub_f32 v15, v15, v8
    v_cvt_pk_bf16_f32 v180, v14, v15
    v_lshlrev_b32 v16, 16, v181
    v_and_b32 v17, s86, v181
    v_add_u32 v4, 0xfffe4000, v4
    v_mfma_f32_32x32x16_bf16 v[96:111], v[248:251], v[172:175], v[96:111]
    ds_read_b64_tr_b16 v[248:249], v4 offset:0
    ds_read_b64_tr_b16 v[250:251], v4 offset:512
    v_sub_f32 v16, v16, v8
    v_sub_f32 v17, v17, v8
    v_cvt_pk_bf16_f32 v181, v16, v17
    v_lshlrev_b32 v14, 16, v182
    v_add_u32 v5, 0xfffe4000, v5
    v_mfma_f32_32x32x16_bf16 v[112:127], v[252:255], v[172:175], v[112:127]
    s_waitcnt lgkmcnt(2)
    ds_read_b64_tr_b16 v[252:253], v5 offset:0
    ds_read_b64_tr_b16 v[254:255], v5 offset:512
    v_and_b32 v15, s86, v182
    v_sub_f32 v14, v14, v8
    v_sub_f32 v15, v15, v8
    v_cvt_pk_bf16_f32 v182, v14, v15
    v_lshlrev_b32 v16, 16, v183
    v_mfma_f32_32x32x16_bf16 v[64:79], v[240:243], v[176:179], v[64:79]
    ds_read_b64_tr_b16 v[240:241], v2 offset:4096
    ds_read_b64_tr_b16 v[242:243], v2 offset:4608
    v_and_b32 v17, s86, v183
    v_sub_f32 v16, v16, v8
    v_sub_f32 v17, v17, v8
    v_cvt_pk_bf16_f32 v183, v16, v17
    v_lshlrev_b32 v14, 16, v184
    v_mfma_f32_32x32x16_bf16 v[80:95], v[244:247], v[176:179], v[80:95]
    s_waitcnt lgkmcnt(2)
    ds_read_b64_tr_b16 v[244:245], v3 offset:4096
    ds_read_b64_tr_b16 v[246:247], v3 offset:4608
    v_and_b32 v15, s86, v184
    v_sub_f32 v14, v14, v8
    v_sub_f32 v15, v15, v8
    v_cvt_pk_bf16_f32 v184, v14, v15
    v_lshlrev_b32 v16, 16, v185
    v_mfma_f32_32x32x16_bf16 v[96:111], v[248:251], v[176:179], v[96:111]
    ds_read_b64_tr_b16 v[248:249], v4 offset:4096
    ds_read_b64_tr_b16 v[250:251], v4 offset:4608
    v_and_b32 v17, s86, v185
    v_sub_f32 v16, v16, v8
    v_sub_f32 v17, v17, v8
    v_cvt_pk_bf16_f32 v185, v16, v17
    v_lshlrev_b32 v14, 16, v186
    v_mfma_f32_32x32x16_bf16 v[112:127], v[252:255], v[176:179], v[112:127]
    s_waitcnt lgkmcnt(2)
    ds_read_b64_tr_b16 v[252:253], v5 offset:4096
    ds_read_b64_tr_b16 v[254:255], v5 offset:4608
    v_and_b32 v15, s86, v186
    v_sub_f32 v14, v14, v8
    v_sub_f32 v15, v15, v8
    v_cvt_pk_bf16_f32 v186, v14, v15
    v_lshlrev_b32 v16, 16, v187
    v_mfma_f32_32x32x16_bf16 v[64:79], v[240:243], v[180:183], v[64:79]
    ds_read_b64_tr_b16 v[240:241], v2 offset:8192
    ds_read_b64_tr_b16 v[242:243], v2 offset:8704
    v_and_b32 v17, s86, v187
    v_sub_f32 v16, v16, v8
    v_sub_f32 v17, v17, v8
    v_cvt_pk_bf16_f32 v187, v16, v17
    v_lshlrev_b32 v14, 16, v188
    v_mfma_f32_32x32x16_bf16 v[80:95], v[244:247], v[180:183], v[80:95]
    s_waitcnt lgkmcnt(2)
    ds_read_b64_tr_b16 v[244:245], v3 offset:8192
    ds_read_b64_tr_b16 v[246:247], v3 offset:8704
    v_and_b32 v15, s86, v188
    v_sub_f32 v14, v14, v8
    v_sub_f32 v15, v15, v8
    v_cvt_pk_bf16_f32 v188, v14, v15
    v_lshlrev_b32 v16, 16, v189
    v_mfma_f32_32x32x16_bf16 v[96:111], v[248:251], v[180:183], v[96:111]
    ds_read_b64_tr_b16 v[248:249], v4 offset:8192
    ds_read_b64_tr_b16 v[250:251], v4 offset:8704
    v_and_b32 v17, s86, v189
    v_sub_f32 v16, v16, v8
    v_sub_f32 v17, v17, v8
    v_cvt_pk_bf16_f32 v189, v16, v17
    v_lshlrev_b32 v14, 16, v190
    v_mfma_f32_32x32x16_bf16 v[112:127], v[252:255], v[180:183], v[112:127]
    s_waitcnt lgkmcnt(2)
    ds_read_b64_tr_b16 v[252:253], v5 offset:8192
    ds_read_b64_tr_b16 v[254:255], v5 offset:8704
    v_and_b32 v15, s86, v190
    v_sub_f32 v14, v14, v8
    v_sub_f32 v15, v15, v8
    v_cvt_pk_bf16_f32 v190, v14, v15
    v_lshlrev_b32 v16, 16, v191
    v_mfma_f32_32x32x16_bf16 v[64:79], v[240:243], v[184:187], v[64:79]
    ds_read_b64_tr_b16 v[240:241], v2 offset:12288
    ds_read_b64_tr_b16 v[242:243], v2 offset:12800
    v_and_b32 v17, s86, v191
    v_sub_f32 v16, v16, v8
    v_sub_f32 v17, v17, v8
    v_cvt_pk_bf16_f32 v191, v16, v17
    v_lshlrev_b32 v14, 16, v192
    v_mfma_f32_32x32x16_bf16 v[80:95], v[244:247], v[184:187], v[80:95]
    s_waitcnt lgkmcnt(2)
    ds_read_b64_tr_b16 v[244:245], v3 offset:12288
    ds_read_b64_tr_b16 v[246:247], v3 offset:12800
    v_and_b32 v15, s86, v192
    v_sub_f32 v14, v14, v8
    v_sub_f32 v15, v15, v8
    v_cvt_pk_bf16_f32 v192, v14, v15
    v_lshlrev_b32 v16, 16, v193
    v_mfma_f32_32x32x16_bf16 v[96:111], v[248:251], v[184:187], v[96:111]
    ds_read_b64_tr_b16 v[248:249], v4 offset:12288
    ds_read_b64_tr_b16 v[250:251], v4 offset:12800
    v_and_b32 v17, s86, v193
    v_sub_f32 v16, v16, v8
    v_sub_f32 v17, v17, v8
    v_cvt_pk_bf16_f32 v193, v16, v17
    v_lshlrev_b32 v14, 16, v194
    v_mfma_f32_32x32x16_bf16 v[112:127], v[252:255], v[184:187], v[112:127]
    s_waitcnt lgkmcnt(2)
    ds_read_b64_tr_b16 v[252:253], v5 offset:12288
    ds_read_b64_tr_b16 v[254:255], v5 offset:12800
    v_and_b32 v15, s86, v194
    v_sub_f32 v14, v14, v8
    v_sub_f32 v15, v15, v8
    v_cvt_pk_bf16_f32 v194, v14, v15
    v_lshlrev_b32 v16, 16, v195
    v_mfma_f32_32x32x16_bf16 v[64:79], v[240:243], v[188:191], v[64:79]
    ds_read_b64_tr_b16 v[240:241], v2 offset:16384
    ds_read_b64_tr_b16 v[242:243], v2 offset:16896
    v_and_b32 v17, s86, v195
    v_sub_f32 v16, v16, v8
    v_sub_f32 v17, v17, v8
    v_cvt_pk_bf16_f32 v195, v16, v17
    v_lshlrev_b32 v14, 16, v196
    v_mfma_f32_32x32x16_bf16 v[80:95], v[244:247], v[188:191], v[80:95]
    s_waitcnt lgkmcnt(2)
    ds_read_b64_tr_b16 v[244:245], v3 offset:16384
    ds_read_b64_tr_b16 v[246:247], v3 offset:16896
    v_and_b32 v15, s86, v196
    v_sub_f32 v14, v14, v8
    v_sub_f32 v15, v15, v8
    v_cvt_pk_bf16_f32 v196, v14, v15
    v_lshlrev_b32 v16, 16, v197
    v_mfma_f32_32x32x16_bf16 v[96:111], v[248:251], v[188:191], v[96:111]
    ds_read_b64_tr_b16 v[248:249], v4 offset:16384
    ds_read_b64_tr_b16 v[250:251], v4 offset:16896
    v_and_b32 v17, s86, v197
    v_sub_f32 v16, v16, v8
    v_sub_f32 v17, v17, v8
    v_cvt_pk_bf16_f32 v197, v16, v17
    v_lshlrev_b32 v14, 16, v198
    v_mfma_f32_32x32x16_bf16 v[112:127], v[252:255], v[188:191], v[112:127]
    s_waitcnt lgkmcnt(2)
    ds_read_b64_tr_b16 v[252:253], v5 offset:16384
    ds_read_b64_tr_b16 v[254:255], v5 offset:16896
    v_and_b32 v15, s86, v198
    v_sub_f32 v14, v14, v8
    v_sub_f32 v15, v15, v8
    v_cvt_pk_bf16_f32 v198, v14, v15
    v_lshlrev_b32 v16, 16, v199
    v_mfma_f32_32x32x16_bf16 v[64:79], v[240:243], v[192:195], v[64:79]
    ds_read_b64_tr_b16 v[240:241], v2 offset:20480
    ds_read_b64_tr_b16 v[242:243], v2 offset:20992
    v_and_b32 v17, s86, v199
    v_sub_f32 v16, v16, v8
    v_sub_f32 v17, v17, v8
    v_cvt_pk_bf16_f32 v199, v16, v17
    v_lshlrev_b32 v14, 16, v200
    v_mfma_f32_32x32x16_bf16 v[80:95], v[244:247], v[192:195], v[80:95]
    s_waitcnt lgkmcnt(2)
    ds_read_b64_tr_b16 v[244:245], v3 offset:20480
    ds_read_b64_tr_b16 v[246:247], v3 offset:20992
    v_and_b32 v15, s86, v200
    v_sub_f32 v14, v14, v8
    v_sub_f32 v15, v15, v8
    v_cvt_pk_bf16_f32 v200, v14, v15
    v_lshlrev_b32 v16, 16, v201
    v_mfma_f32_32x32x16_bf16 v[96:111], v[248:251], v[192:195], v[96:111]
    ds_read_b64_tr_b16 v[248:249], v4 offset:20480
    ds_read_b64_tr_b16 v[250:251], v4 offset:20992
    v_and_b32 v17, s86, v201
    v_sub_f32 v16, v16, v8
    v_sub_f32 v17, v17, v8
    v_cvt_pk_bf16_f32 v201, v16, v17
    v_lshlrev_b32 v14, 16, v202
    v_mfma_f32_32x32x16_bf16 v[112:127], v[252:255], v[192:195], v[112:127]
    s_waitcnt lgkmcnt(2)
    ds_read_b64_tr_b16 v[252:253], v5 offset:20480
    ds_read_b64_tr_b16 v[254:255], v5 offset:20992
    v_and_b32 v15, s86, v202
    v_sub_f32 v14, v14, v8
    v_sub_f32 v15, v15, v8
    v_cvt_pk_bf16_f32 v202, v14, v15
    v_lshlrev_b32 v16, 16, v203
    v_mfma_f32_32x32x16_bf16 v[64:79], v[240:243], v[196:199], v[64:79]
    ds_read_b64_tr_b16 v[240:241], v2 offset:24576
    ds_read_b64_tr_b16 v[242:243], v2 offset:25088
    v_and_b32 v17, s86, v203
    v_sub_f32 v16, v16, v8
    v_sub_f32 v17, v17, v8
    v_cvt_pk_bf16_f32 v203, v16, v17
    v_lshlrev_b32 v14, 16, v204
    v_mfma_f32_32x32x16_bf16 v[80:95], v[244:247], v[196:199], v[80:95]
    s_waitcnt lgkmcnt(2)
    ds_read_b64_tr_b16 v[244:245], v3 offset:24576
    ds_read_b64_tr_b16 v[246:247], v3 offset:25088
    v_and_b32 v15, s86, v204
    v_sub_f32 v14, v14, v8
    v_sub_f32 v15, v15, v8
    v_cvt_pk_bf16_f32 v204, v14, v15
    v_lshlrev_b32 v16, 16, v205
    v_mfma_f32_32x32x16_bf16 v[96:111], v[248:251], v[196:199], v[96:111]
    ds_read_b64_tr_b16 v[248:249], v4 offset:24576
    ds_read_b64_tr_b16 v[250:251], v4 offset:25088
    v_and_b32 v17, s86, v205
    v_sub_f32 v16, v16, v8
    v_sub_f32 v17, v17, v8
    v_cvt_pk_bf16_f32 v205, v16, v17
    v_lshlrev_b32 v14, 16, v206
    v_mfma_f32_32x32x16_bf16 v[112:127], v[252:255], v[196:199], v[112:127]
    s_waitcnt lgkmcnt(2)
    ds_read_b64_tr_b16 v[252:253], v5 offset:24576
    ds_read_b64_tr_b16 v[254:255], v5 offset:25088
    v_and_b32 v15, s86, v206
    v_sub_f32 v14, v14, v8
    v_sub_f32 v15, v15, v8
    v_cvt_pk_bf16_f32 v206, v14, v15
    v_lshlrev_b32 v16, 16, v207
    v_mfma_f32_32x32x16_bf16 v[64:79], v[240:243], v[200:203], v[64:79]
    ds_read_b64_tr_b16 v[240:241], v2 offset:28672
    ds_read_b64_tr_b16 v[242:243], v2 offset:29184
    v_and_b32 v17, s86, v207
    v_sub_f32 v16, v16, v8
    v_sub_f32 v17, v17, v8
    v_cvt_pk_bf16_f32 v207, v16, v17
    v_lshlrev_b32 v14, 16, v208
    v_mfma_f32_32x32x16_bf16 v[80:95], v[244:247], v[200:203], v[80:95]
    s_waitcnt lgkmcnt(2)
    ds_read_b64_tr_b16 v[244:245], v3 offset:28672
    ds_read_b64_tr_b16 v[246:247], v3 offset:29184
    v_and_b32 v15, s86, v208
    v_sub_f32 v14, v14, v8
    v_sub_f32 v15, v15, v8
    v_cvt_pk_bf16_f32 v208, v14, v15
    v_lshlrev_b32 v16, 16, v209
    v_mfma_f32_32x32x16_bf16 v[96:111], v[248:251], v[200:203], v[96:111]
    ds_read_b64_tr_b16 v[248:249], v4 offset:28672
    ds_read_b64_tr_b16 v[250:251], v4 offset:29184
    v_and_b32 v17, s86, v209
    v_sub_f32 v16, v16, v8
    v_sub_f32 v17, v17, v8
    v_cvt_pk_bf16_f32 v209, v16, v17
    v_lshlrev_b32 v14, 16, v210
    v_mfma_f32_32x32x16_bf16 v[112:127], v[252:255], v[200:203], v[112:127]
    s_waitcnt lgkmcnt(2)
    ds_read_b64_tr_b16 v[252:253], v5 offset:28672
    ds_read_b64_tr_b16 v[254:255], v5 offset:29184
    v_and_b32 v15, s86, v210
    v_sub_f32 v14, v14, v8
    v_sub_f32 v15, v15, v8
    v_cvt_pk_bf16_f32 v210, v14, v15
    v_lshlrev_b32 v16, 16, v211
    v_mfma_f32_32x32x16_bf16 v[64:79], v[240:243], v[204:207], v[64:79]
    s_barrier
    ds_read_b64_tr_b16 v[240:241], v2 offset:32768
    ds_read_b64_tr_b16 v[242:243], v2 offset:33280
    v_and_b32 v17, s86, v211
    v_sub_f32 v16, v16, v8
    v_sub_f32 v17, v17, v8
    v_cvt_pk_bf16_f32 v211, v16, v17
    v_lshlrev_b32 v14, 16, v212
    v_mfma_f32_32x32x16_bf16 v[80:95], v[244:247], v[204:207], v[80:95]
    s_waitcnt lgkmcnt(2)
    ds_read_b64_tr_b16 v[244:245], v3 offset:32768
    ds_read_b64_tr_b16 v[246:247], v3 offset:33280
    v_and_b32 v15, s86, v212
    v_sub_f32 v14, v14, v8
    v_sub_f32 v15, v15, v8
    v_cvt_pk_bf16_f32 v212, v14, v15
    v_lshlrev_b32 v16, 16, v213
    v_mfma_f32_32x32x16_bf16 v[96:111], v[248:251], v[204:207], v[96:111]
    ds_read_b64_tr_b16 v[248:249], v4 offset:32768
    ds_read_b64_tr_b16 v[250:251], v4 offset:33280
    v_and_b32 v17, s86, v213
    v_sub_f32 v16, v16, v8
    v_sub_f32 v17, v17, v8
    v_cvt_pk_bf16_f32 v213, v16, v17
    v_lshlrev_b32 v14, 16, v214
    v_mfma_f32_32x32x16_bf16 v[112:127], v[252:255], v[204:207], v[112:127]
    s_waitcnt lgkmcnt(2)
    ds_read_b64_tr_b16 v[252:253], v5 offset:32768
    ds_read_b64_tr_b16 v[254:255], v5 offset:33280
    v_and_b32 v15, s86, v214
    v_sub_f32 v14, v14, v8
    v_sub_f32 v15, v15, v8
    v_cvt_pk_bf16_f32 v214, v14, v15
    v_lshlrev_b32 v16, 16, v215
    v_mfma_f32_32x32x16_bf16 v[64:79], v[240:243], v[208:211], v[64:79]
    ds_read_b64_tr_b16 v[240:241], v2 offset:36864
    ds_read_b64_tr_b16 v[242:243], v2 offset:37376
    v_and_b32 v17, s86, v215
    v_sub_f32 v16, v16, v8
    v_sub_f32 v17, v17, v8
    v_cvt_pk_bf16_f32 v215, v16, v17
    v_lshlrev_b32 v14, 16, v216
    v_mfma_f32_32x32x16_bf16 v[80:95], v[244:247], v[208:211], v[80:95]
    s_waitcnt lgkmcnt(2)
    ds_read_b64_tr_b16 v[244:245], v3 offset:36864
    ds_read_b64_tr_b16 v[246:247], v3 offset:37376
    v_and_b32 v15, s86, v216
    v_sub_f32 v14, v14, v8
    v_sub_f32 v15, v15, v8
    v_cvt_pk_bf16_f32 v216, v14, v15
    v_lshlrev_b32 v16, 16, v217
    v_mfma_f32_32x32x16_bf16 v[96:111], v[248:251], v[208:211], v[96:111]
    ds_read_b64_tr_b16 v[248:249], v4 offset:36864
    ds_read_b64_tr_b16 v[250:251], v4 offset:37376
    v_and_b32 v17, s86, v217
    v_sub_f32 v16, v16, v8
    v_sub_f32 v17, v17, v8
    v_cvt_pk_bf16_f32 v217, v16, v17
    v_lshlrev_b32 v14, 16, v218
    v_mfma_f32_32x32x16_bf16 v[112:127], v[252:255], v[208:211], v[112:127]
    s_waitcnt lgkmcnt(2)
    ds_read_b64_tr_b16 v[252:253], v5 offset:36864
    ds_read_b64_tr_b16 v[254:255], v5 offset:37376
    v_and_b32 v15, s86, v218
    v_sub_f32 v14, v14, v8
    v_sub_f32 v15, v15, v8
    v_cvt_pk_bf16_f32 v218, v14, v15
    v_lshlrev_b32 v16, 16, v219
    v_mfma_f32_32x32x16_bf16 v[64:79], v[240:243], v[212:215], v[64:79]
    ds_read_b64_tr_b16 v[240:241], v2 offset:40960
    ds_read_b64_tr_b16 v[242:243], v2 offset:41472
    v_and_b32 v17, s86, v219
    v_sub_f32 v16, v16, v8
    v_sub_f32 v17, v17, v8
    v_cvt_pk_bf16_f32 v219, v16, v17
    v_lshlrev_b32 v14, 16, v220
    v_mfma_f32_32x32x16_bf16 v[80:95], v[244:247], v[212:215], v[80:95]
    s_waitcnt lgkmcnt(2)
    ds_read_b64_tr_b16 v[244:245], v3 offset:40960
    ds_read_b64_tr_b16 v[246:247], v3 offset:41472
    v_and_b32 v15, s86, v220
    v_sub_f32 v14, v14, v8
    v_sub_f32 v15, v15, v8
    v_cvt_pk_bf16_f32 v220, v14, v15
    v_lshlrev_b32 v16, 16, v221
    v_mfma_f32_32x32x16_bf16 v[96:111], v[248:251], v[212:215], v[96:111]
    ds_read_b64_tr_b16 v[248:249], v4 offset:40960
    ds_read_b64_tr_b16 v[250:251], v4 offset:41472
    v_and_b32 v17, s86, v221
    v_sub_f32 v16, v16, v8
    v_sub_f32 v17, v17, v8
    v_cvt_pk_bf16_f32 v221, v16, v17
    v_lshlrev_b32 v14, 16, v222
    v_mfma_f32_32x32x16_bf16 v[112:127], v[252:255], v[212:215], v[112:127]
    s_waitcnt lgkmcnt(2)
    ds_read_b64_tr_b16 v[252:253], v5 offset:40960
    ds_read_b64_tr_b16 v[254:255], v5 offset:41472
    v_and_b32 v15, s86, v222
    v_sub_f32 v14, v14, v8
    v_sub_f32 v15, v15, v8
    v_cvt_pk_bf16_f32 v222, v14, v15
    v_lshlrev_b32 v16, 16, v223
    v_mfma_f32_32x32x16_bf16 v[64:79], v[240:243], v[216:219], v[64:79]
    ds_read_b64_tr_b16 v[240:241], v2 offset:45056
    ds_read_b64_tr_b16 v[242:243], v2 offset:45568
    v_and_b32 v17, s86, v223
    v_sub_f32 v16, v16, v8
    v_sub_f32 v17, v17, v8
    v_cvt_pk_bf16_f32 v223, v16, v17
    v_lshlrev_b32 v14, 16, v224
    v_mfma_f32_32x32x16_bf16 v[80:95], v[244:247], v[216:219], v[80:95]
    s_waitcnt lgkmcnt(2)
    ds_read_b64_tr_b16 v[244:245], v3 offset:45056
    ds_read_b64_tr_b16 v[246:247], v3 offset:45568
    v_and_b32 v15, s86, v224
    v_sub_f32 v14, v14, v8
    v_sub_f32 v15, v15, v8
    v_cvt_pk_bf16_f32 v224, v14, v15
    v_lshlrev_b32 v16, 16, v225
    v_mfma_f32_32x32x16_bf16 v[96:111], v[248:251], v[216:219], v[96:111]
    ds_read_b64_tr_b16 v[248:249], v4 offset:45056
    ds_read_b64_tr_b16 v[250:251], v4 offset:45568
    v_and_b32 v17, s86, v225
    v_sub_f32 v16, v16, v8
    v_sub_f32 v17, v17, v8
    v_cvt_pk_bf16_f32 v225, v16, v17
    v_lshlrev_b32 v14, 16, v226
    v_mfma_f32_32x32x16_bf16 v[112:127], v[252:255], v[216:219], v[112:127]
    s_waitcnt lgkmcnt(2)
    ds_read_b64_tr_b16 v[252:253], v5 offset:45056
    ds_read_b64_tr_b16 v[254:255], v5 offset:45568
    v_and_b32 v15, s86, v226
    v_sub_f32 v14, v14, v8
    v_sub_f32 v15, v15, v8
    v_cvt_pk_bf16_f32 v226, v14, v15
    v_lshlrev_b32 v16, 16, v227
    v_mfma_f32_32x32x16_bf16 v[64:79], v[240:243], v[220:223], v[64:79]
    ds_read_b64_tr_b16 v[240:241], v2 offset:49152
    ds_read_b64_tr_b16 v[242:243], v2 offset:49664
    v_and_b32 v17, s86, v227
    v_sub_f32 v16, v16, v8
    v_sub_f32 v17, v17, v8
    v_cvt_pk_bf16_f32 v227, v16, v17
    v_lshlrev_b32 v14, 16, v228
    v_mfma_f32_32x32x16_bf16 v[80:95], v[244:247], v[220:223], v[80:95]
    s_waitcnt lgkmcnt(2)
    ds_read_b64_tr_b16 v[244:245], v3 offset:49152
    ds_read_b64_tr_b16 v[246:247], v3 offset:49664
    v_and_b32 v15, s86, v228
    v_sub_f32 v14, v14, v8
    v_sub_f32 v15, v15, v8
    v_cvt_pk_bf16_f32 v228, v14, v15
    v_lshlrev_b32 v16, 16, v229
    v_mfma_f32_32x32x16_bf16 v[96:111], v[248:251], v[220:223], v[96:111]
    ds_read_b64_tr_b16 v[248:249], v4 offset:49152
    ds_read_b64_tr_b16 v[250:251], v4 offset:49664
    v_and_b32 v17, s86, v229
    v_sub_f32 v16, v16, v8
    v_sub_f32 v17, v17, v8
    v_cvt_pk_bf16_f32 v229, v16, v17
    v_lshlrev_b32 v14, 16, v230
    v_mfma_f32_32x32x16_bf16 v[112:127], v[252:255], v[220:223], v[112:127]
    s_waitcnt lgkmcnt(2)
    ds_read_b64_tr_b16 v[252:253], v5 offset:49152
    ds_read_b64_tr_b16 v[254:255], v5 offset:49664
    v_and_b32 v15, s86, v230
    v_sub_f32 v14, v14, v8
    v_sub_f32 v15, v15, v8
    v_cvt_pk_bf16_f32 v230, v14, v15
    v_lshlrev_b32 v16, 16, v231
    v_mfma_f32_32x32x16_bf16 v[64:79], v[240:243], v[224:227], v[64:79]
    ds_read_b64_tr_b16 v[240:241], v2 offset:53248
    ds_read_b64_tr_b16 v[242:243], v2 offset:53760
    v_and_b32 v17, s86, v231
    v_sub_f32 v16, v16, v8
    v_sub_f32 v17, v17, v8
    v_cvt_pk_bf16_f32 v231, v16, v17
    v_lshlrev_b32 v14, 16, v232
    v_mfma_f32_32x32x16_bf16 v[80:95], v[244:247], v[224:227], v[80:95]
    s_waitcnt lgkmcnt(2)
    ds_read_b64_tr_b16 v[244:245], v3 offset:53248
    ds_read_b64_tr_b16 v[246:247], v3 offset:53760
    v_and_b32 v15, s86, v232
    v_sub_f32 v14, v14, v8
    v_sub_f32 v15, v15, v8
    v_cvt_pk_bf16_f32 v232, v14, v15
    v_lshlrev_b32 v16, 16, v233
    v_mfma_f32_32x32x16_bf16 v[96:111], v[248:251], v[224:227], v[96:111]
    ds_read_b64_tr_b16 v[248:249], v4 offset:53248
    ds_read_b64_tr_b16 v[250:251], v4 offset:53760
    v_and_b32 v17, s86, v233
    v_sub_f32 v16, v16, v8
    v_sub_f32 v17, v17, v8
    v_cvt_pk_bf16_f32 v233, v16, v17
    v_lshlrev_b32 v14, 16, v234
    v_mfma_f32_32x32x16_bf16 v[112:127], v[252:255], v[224:227], v[112:127]
    s_waitcnt lgkmcnt(2)
    ds_read_b64_tr_b16 v[252:253], v5 offset:53248
    ds_read_b64_tr_b16 v[254:255], v5 offset:53760
    v_and_b32 v15, s86, v234
    v_sub_f32 v14, v14, v8
    v_sub_f32 v15, v15, v8
    v_cvt_pk_bf16_f32 v234, v14, v15
    v_lshlrev_b32 v16, 16, v235
    v_mfma_f32_32x32x16_bf16 v[64:79], v[240:243], v[228:231], v[64:79]
    ds_read_b64_tr_b16 v[240:241], v2 offset:57344
    ds_read_b64_tr_b16 v[242:243], v2 offset:57856
    v_and_b32 v17, s86, v235
    v_sub_f32 v16, v16, v8
    v_sub_f32 v17, v17, v8
    v_cvt_pk_bf16_f32 v235, v16, v17
    v_lshlrev_b32 v14, 16, v236
    v_mfma_f32_32x32x16_bf16 v[80:95], v[244:247], v[228:231], v[80:95]
    s_waitcnt lgkmcnt(2)
    ds_read_b64_tr_b16 v[244:245], v3 offset:57344
    ds_read_b64_tr_b16 v[246:247], v3 offset:57856
    v_and_b32 v15, s86, v236
    v_sub_f32 v14, v14, v8
    v_sub_f32 v15, v15, v8
    v_cvt_pk_bf16_f32 v236, v14, v15
    v_lshlrev_b32 v16, 16, v237
    v_mfma_f32_32x32x16_bf16 v[96:111], v[248:251], v[228:231], v[96:111]
    ds_read_b64_tr_b16 v[248:249], v4 offset:57344
    ds_read_b64_tr_b16 v[250:251], v4 offset:57856
    v_and_b32 v17, s86, v237
    v_sub_f32 v16, v16, v8
    v_sub_f32 v17, v17, v8
    v_cvt_pk_bf16_f32 v237, v16, v17
    v_lshlrev_b32 v14, 16, v238
    v_mfma_f32_32x32x16_bf16 v[112:127], v[252:255], v[228:231], v[112:127]
    s_waitcnt lgkmcnt(2)
    ds_read_b64_tr_b16 v[252:253], v5 offset:57344
    ds_read_b64_tr_b16 v[254:255], v5 offset:57856
    v_and_b32 v15, s86, v238
    v_sub_f32 v14, v14, v8
    v_sub_f32 v15, v15, v8
    v_cvt_pk_bf16_f32 v238, v14, v15
    v_lshlrev_b32 v16, 16, v239
    v_mfma_f32_32x32x16_bf16 v[64:79], v[240:243], v[232:235], v[64:79]
    ds_read_b64_tr_b16 v[240:241], v2 offset:61440
    ds_read_b64_tr_b16 v[242:243], v2 offset:61952
    v_and_b32 v17, s86, v239
    v_sub_f32 v16, v16, v8
    v_sub_f32 v17, v17, v8
    v_cvt_pk_bf16_f32 v239, v16, v17
    v_mfma_f32_32x32x16_bf16 v[80:95], v[244:247], v[232:235], v[80:95]
    s_waitcnt lgkmcnt(2)
    ds_read_b64_tr_b16 v[244:245], v3 offset:61440
    ds_read_b64_tr_b16 v[246:247], v3 offset:61952
    v_mfma_f32_32x32x16_bf16 v[96:111], v[248:251], v[232:235], v[96:111]
    ds_read_b64_tr_b16 v[248:249], v4 offset:61440
    ds_read_b64_tr_b16 v[250:251], v4 offset:61952
    v_mfma_f32_32x32x16_bf16 v[112:127], v[252:255], v[232:235], v[112:127]
    s_waitcnt lgkmcnt(2)
    ds_read_b64_tr_b16 v[252:253], v5 offset:61440
    ds_read_b64_tr_b16 v[254:255], v5 offset:61952
    v_add_u32 v2, 0x10000, v2
    v_mfma_f32_32x32x16_bf16 v[64:79], v[240:243], v[236:239], v[64:79]
    s_barrier
    ds_read_b64_tr_b16 v[240:241], v2 offset:0
    ds_read_b64_tr_b16 v[242:243], v2 offset:512
    v_add_u32 v3, 0x10000, v3
    v_mfma_f32_32x32x16_bf16 v[80:95], v[244:247], v[236:239], v[80:95]
    s_waitcnt lgkmcnt(2)
    ds_read_b64_tr_b16 v[244:245], v3 offset:0
    ds_read_b64_tr_b16 v[246:247], v3 offset:512
    v_mfma_f32_32x32x16_bf16 v[96:111], v[248:251], v[236:239], v[96:111]
    ds_read_b64_tr_b16 v[248:249], v2 offset:4096
    ds_read_b64_tr_b16 v[250:251], v2 offset:4608
    v_mfma_f32_32x32x16_bf16 v[112:127], v[252:255], v[236:239], v[112:127]
    s_waitcnt lgkmcnt(2)
    ds_read_b64_tr_b16 v[252:253], v3 offset:4096
    ds_read_b64_tr_b16 v[254:255], v3 offset:4608
    v_mfma_f32_32x32x16_bf16 v[32:47], v[240:243], v[128:131], 0
    ds_read_b64_tr_b16 v[240:241], v2 offset:8192
    ds_read_b64_tr_b16 v[242:243], v2 offset:8704
    v_mul_f32 v14, v64, v10
    v_exp_f32 v14, v14
    v_mul_f32 v64, v64, v72
    v_mfma_f32_32x32x16_bf16 v[48:63], v[244:247], v[128:131], 0
    s_waitcnt lgkmcnt(2)
    ds_read_b64_tr_b16 v[244:245], v3 offset:8192
    ds_read_b64_tr_b16 v[246:247], v3 offset:8704
    v_fma_f32 v14, v14, v9, v9
    v_rcp_f32 v14, v14
    v_mul_f32 v15, v65, v10
    v_mfma_f32_32x32x16_bf16 v[32:47], v[248:251], v[132:135], v[32:47]
    ds_read_b64_tr_b16 v[248:249], v2 offset:12288
    ds_read_b64_tr_b16 v[250:251], v2 offset:12800
    v_mul_f32 v64, v64, v14
    v_exp_f32 v15, v15
    v_mul_f32 v65, v65, v73
    v_mfma_f32_32x32x16_bf16 v[48:63], v[252:255], v[132:135], v[48:63]
    s_waitcnt lgkmcnt(2)
    ds_read_b64_tr_b16 v[252:253], v3 offset:12288
    ds_read_b64_tr_b16 v[254:255], v3 offset:12800
    v_fma_f32 v15, v15, v9, v9
    v_rcp_f32 v15, v15
    v_mfma_f32_32x32x16_bf16 v[32:47], v[240:243], v[136:139], v[32:47]
    ds_read_b64_tr_b16 v[240:241], v2 offset:16384
    ds_read_b64_tr_b16 v[242:243], v2 offset:16896
    v_mul_f32 v16, v66, v10
    v_mul_f32 v65, v65, v15
    v_cvt_pk_bf16_f32 v20, v64, v65
    v_mfma_f32_32x32x16_bf16 v[48:63], v[244:247], v[136:139], v[48:63]
    s_waitcnt lgkmcnt(2)
    ds_read_b64_tr_b16 v[244:245], v3 offset:16384
    ds_read_b64_tr_b16 v[246:247], v3 offset:16896
    v_exp_f32 v16, v16
    v_mul_f32 v66, v66, v74
    v_fma_f32 v16, v16, v9, v9
    v_mfma_f32_32x32x16_bf16 v[32:47], v[248:251], v[140:143], v[32:47]
    ds_read_b64_tr_b16 v[248:249], v2 offset:20480
    ds_read_b64_tr_b16 v[250:251], v2 offset:20992
    v_rcp_f32 v16, v16
    v_mul_f32 v14, v67, v10
    v_mul_f32 v66, v66, v16
    v_mfma_f32_32x32x16_bf16 v[48:63], v[252:255], v[140:143], v[48:63]
    s_waitcnt lgkmcnt(2)
    ds_read_b64_tr_b16 v[252:253], v3 offset:20480
    ds_read_b64_tr_b16 v[254:255], v3 offset:20992
    v_exp_f32 v14, v14
    v_mul_f32 v67, v67, v75
    v_fma_f32 v14, v14, v9, v9
    v_mfma_f32_32x32x16_bf16 v[32:47], v[240:243], v[144:147], v[32:47]
    ds_read_b64_tr_b16 v[240:241], v2 offset:24576
    ds_read_b64_tr_b16 v[242:243], v2 offset:25088
    v_rcp_f32 v14, v14
    v_mul_f32 v15, v68, v10
    v_mul_f32 v67, v67, v14
    v_mfma_f32_32x32x16_bf16 v[48:63], v[244:247], v[144:147], v[48:63]
    s_waitcnt lgkmcnt(2)
    ds_read_b64_tr_b16 v[244:245], v3 offset:24576
    ds_read_b64_tr_b16 v[246:247], v3 offset:25088
    v_cvt_pk_bf16_f32 v21, v66, v67
    v_exp_f32 v15, v15
    v_mul_f32 v68, v68, v76
    v_mfma_f32_32x32x16_bf16 v[32:47], v[248:251], v[148:151], v[32:47]
    ds_read_b64_tr_b16 v[248:249], v2 offset:28672
    ds_read_b64_tr_b16 v[250:251], v2 offset:29184
    v_fma_f32 v15, v15, v9, v9
    v_rcp_f32 v15, v15
    v_mul_f32 v16, v69, v10
    v_mfma_f32_32x32x16_bf16 v[48:63], v[252:255], v[148:151], v[48:63]
    s_waitcnt lgkmcnt(2)
    ds_read_b64_tr_b16 v[252:253], v3 offset:28672
    ds_read_b64_tr_b16 v[254:255], v3 offset:29184
    v_mul_f32 v68, v68, v15
    v_exp_f32 v16, v16
    v_mfma_f32_32x32x16_bf16 v[32:47], v[240:243], v[152:155], v[32:47]
    ds_read_b64_tr_b16 v[240:241], v2 offset:32768
    ds_read_b64_tr_b16 v[242:243], v2 offset:33280
    v_mul_f32 v69, v69, v77
    v_fma_f32 v16, v16, v9, v9
    v_rcp_f32 v16, v16
    v_mfma_f32_32x32x16_bf16 v[48:63], v[244:247], v[152:155], v[48:63]
    s_waitcnt lgkmcnt(2)
    ds_read_b64_tr_b16 v[244:245], v3 offset:32768
    ds_read_b64_tr_b16 v[246:247], v3 offset:33280
    v_mul_f32 v14, v70, v10
    v_mul_f32 v69, v69, v16
    v_cvt_pk_bf16_f32 v22, v68, v69
    v_mfma_f32_32x32x16_bf16 v[32:47], v[248:251], v[156:159], v[32:47]
    ds_read_b64_tr_b16 v[248:249], v2 offset:36864
    ds_read_b64_tr_b16 v[250:251], v2 offset:37376
    v_exp_f32 v14, v14
    v_mul_f32 v70, v70, v78
    v_fma_f32 v14, v14, v9, v9
    v_mfma_f32_32x32x16_bf16 v[48:63], v[252:255], v[156:159], v[48:63]
    s_waitcnt lgkmcnt(2)
    ds_read_b64_tr_b16 v[252:253], v3 offset:36864
    ds_read_b64_tr_b16 v[254:255], v3 offset:37376
    v_rcp_f32 v14, v14
    v_mul_f32 v15, v71, v10
    v_mul_f32 v70, v70, v14
    v_mfma_f32_32x32x16_bf16 v[32:47], v[240:243], v[160:163], v[32:47]
    ds_read_b64_tr_b16 v[240:241], v2 offset:40960
    ds_read_b64_tr_b16 v[242:243], v2 offset:41472
    v_exp_f32 v15, v15
    v_mul_f32 v71, v71, v79
    v_fma_f32 v15, v15, v9, v9
    v_mfma_f32_32x32x16_bf16 v[48:63], v[244:247], v[160:163], v[48:63]
    s_waitcnt lgkmcnt(2)
    ds_read_b64_tr_b16 v[244:245], v3 offset:40960
    ds_read_b64_tr_b16 v[246:247], v3 offset:41472
    v_rcp_f32 v15, v15
    s_nop 0
    v_mul_f32 v71, v71, v15
    v_cvt_pk_bf16_f32 v23, v70, v71
    v_mfma_f32_32x32x16_bf16 v[32:47], v[248:251], v[164:167], v[32:47]
    ds_read_b64_tr_b16 v[248:249], v2 offset:45056
    ds_read_b64_tr_b16 v[250:251], v2 offset:45568
    v_mul_f32 v14, v80, v10
    v_exp_f32 v14, v14
    v_mfma_f32_32x32x16_bf16 v[48:63], v[252:255], v[164:167], v[48:63]
    s_waitcnt lgkmcnt(2)
    ds_read_b64_tr_b16 v[252:253], v3 offset:45056
    ds_read_b64_tr_b16 v[254:255], v3 offset:45568
    v_mul_f32 v80, v80, v88
    v_fma_f32 v14, v14, v9, v9
    v_rcp_f32 v14, v14
    v_mfma_f32_32x32x16_bf16 v[32:47], v[240:243], v[168:171], v[32:47]
    s_barrier
    ds_read_b64_tr_b16 v[240:241], v2 offset:49152
    ds_read_b64_tr_b16 v[242:243], v2 offset:49664
    v_mul_f32 v15, v81, v10
    v_mul_f32 v80, v80, v14
    v_exp_f32 v15, v15
    v_mfma_f32_32x32x16_bf16 v[48:63], v[244:247], v[168:171], v[48:63]
    s_waitcnt lgkmcnt(2)
    ds_read_b64_tr_b16 v[244:245], v3 offset:49152
    ds_read_b64_tr_b16 v[246:247], v3 offset:49664
    v_mul_f32 v81, v81, v89
    v_fma_f32 v15, v15, v9, v9
    v_rcp_f32 v15, v15
    v_mfma_f32_32x32x16_bf16 v[32:47], v[248:251], v[172:175], v[32:47]
    ds_read_b64_tr_b16 v[248:249], v2 offset:53248
    ds_read_b64_tr_b16 v[250:251], v2 offset:53760
    v_mul_f32 v16, v82, v10
    v_mul_f32 v81, v81, v15
    v_cvt_pk_bf16_f32 v24, v80, v81
    v_mfma_f32_32x32x16_bf16 v[48:63], v[252:255], v[172:175], v[48:63]
    s_waitcnt lgkmcnt(2)
    ds_read_b64_tr_b16 v[252:253], v3 offset:53248
    ds_read_b64_tr_b16 v[254:255], v3 offset:53760
    v_exp_f32 v16, v16
    v_mul_f32 v82, v82, v90
    v_fma_f32 v16, v16, v9, v9
    v_mfma_f32_32x32x16_bf16 v[32:47], v[240:243], v[176:179], v[32:47]
    ds_read_b64_tr_b16 v[240:241], v2 offset:57344
    ds_read_b64_tr_b16 v[242:243], v2 offset:57856
    v_rcp_f32 v16, v16
    v_mul_f32 v14, v83, v10
    v_mul_f32 v82, v82, v16
    v_mfma_f32_32x32x16_bf16 v[48:63], v[244:247], v[176:179], v[48:63]
    s_waitcnt lgkmcnt(2)
    ds_read_b64_tr_b16 v[244:245], v3 offset:57344
    ds_read_b64_tr_b16 v[246:247], v3 offset:57856
    v_exp_f32 v14, v14
    v_mul_f32 v83, v83, v91
    v_fma_f32 v14, v14, v9, v9
    v_mfma_f32_32x32x16_bf16 v[32:47], v[248:251], v[180:183], v[32:47]
    ds_read_b64_tr_b16 v[248:249], v2 offset:61440
    ds_read_b64_tr_b16 v[250:251], v2 offset:61952
    v_rcp_f32 v14, v14
    v_mul_f32 v15, v84, v10
    v_mfma_f32_32x32x16_bf16 v[48:63], v[252:255], v[180:183], v[48:63]
    s_waitcnt lgkmcnt(2)
    ds_read_b64_tr_b16 v[252:253], v3 offset:61440
    ds_read_b64_tr_b16 v[254:255], v3 offset:61952
    v_mul_f32 v83, v83, v14
    v_cvt_pk_bf16_f32 v25, v82, v83
    v_add_u32 v2, 0xc000, v2
    v_mfma_f32_32x32x16_bf16 v[32:47], v[240:243], v[184:187], v[32:47]
    ds_read_b64_tr_b16 v[240:241], v2 offset:16384
    ds_read_b64_tr_b16 v[242:243], v2 offset:16896
    v_exp_f32 v15, v15
    v_mul_f32 v84, v84, v92
    v_add_u32 v3, 0xc000, v3
    v_mfma_f32_32x32x16_bf16 v[48:63], v[244:247], v[184:187], v[48:63]
    s_waitcnt lgkmcnt(2)
    ds_read_b64_tr_b16 v[244:245], v3 offset:16384
    ds_read_b64_tr_b16 v[246:247], v3 offset:16896
    v_fma_f32 v15, v15, v9, v9
    v_rcp_f32 v15, v15
    v_mul_f32 v16, v85, v10
    v_mfma_f32_32x32x16_bf16 v[32:47], v[248:251], v[188:191], v[32:47]
    ds_read_b64_tr_b16 v[248:249], v2 offset:20480
    ds_read_b64_tr_b16 v[250:251], v2 offset:20992
    v_mul_f32 v84, v84, v15
    v_exp_f32 v16, v16
    v_mul_f32 v85, v85, v93
    v_mfma_f32_32x32x16_bf16 v[48:63], v[252:255], v[188:191], v[48:63]
    s_waitcnt lgkmcnt(2)
    ds_read_b64_tr_b16 v[252:253], v3 offset:20480
    ds_read_b64_tr_b16 v[254:255], v3 offset:20992
    v_fma_f32 v16, v16, v9, v9
    v_rcp_f32 v16, v16
    v_mul_f32 v14, v86, v10
    v_mfma_f32_32x32x16_bf16 v[32:47], v[240:243], v[192:195], v[32:47]
    ds_read_b64_tr_b16 v[240:241], v2 offset:24576
    ds_read_b64_tr_b16 v[242:243], v2 offset:25088
    v_mul_f32 v85, v85, v16
    v_cvt_pk_bf16_f32 v26, v84, v85
    v_exp_f32 v14, v14
    v_mfma_f32_32x32x16_bf16 v[48:63], v[244:247], v[192:195], v[48:63]
    s_waitcnt lgkmcnt(2)
    ds_read_b64_tr_b16 v[244:245], v3 offset:24576
    ds_read_b64_tr_b16 v[246:247], v3 offset:25088
    v_mul_f32 v86, v86, v94
    v_fma_f32 v14, v14, v9, v9
    v_rcp_f32 v14, v14
    v_mfma_f32_32x32x16_bf16 v[32:47], v[248:251], v[196:199], v[32:47]
    ds_read_b64_tr_b16 v[248:249], v2 offset:28672
    ds_read_b64_tr_b16 v[250:251], v2 offset:29184
    v_mul_f32 v15, v87, v10
    v_mul_f32 v86, v86, v14
    v_exp_f32 v15, v15
    v_mfma_f32_32x32x16_bf16 v[48:63], v[252:255], v[196:199], v[48:63]
    s_waitcnt lgkmcnt(2)
    ds_read_b64_tr_b16 v[252:253], v3 offset:28672
    ds_read_b64_tr_b16 v[254:255], v3 offset:29184
    v_mul_f32 v87, v87, v95
    v_fma_f32 v15, v15, v9, v9
    v_rcp_f32 v15, v15
    v_mfma_f32_32x32x16_bf16 v[32:47], v[240:243], v[200:203], v[32:47]
    ds_read_b64_tr_b16 v[240:241], v2 offset:32768
    ds_read_b64_tr_b16 v[242:243], v2 offset:33280
    v_mul_f32 v87, v87, v15
    v_cvt_pk_bf16_f32 v27, v86, v87
    v_mul_f32 v14, v112, v10
    v_mfma_f32_32x32x16_bf16 v[48:63], v[244:247], v[200:203], v[48:63]
    s_waitcnt lgkmcnt(2)
    ds_read_b64_tr_b16 v[244:245], v3 offset:32768
    ds_read_b64_tr_b16 v[246:247], v3 offset:33280
    v_exp_f32 v14, v14
    v_mul_f32 v112, v112, v120
    v_fma_f32 v14, v14, v9, v9
    v_mfma_f32_32x32x16_bf16 v[32:47], v[248:251], v[204:207], v[32:47]
    ds_read_b64_tr_b16 v[248:249], v2 offset:36864
    ds_read_b64_tr_b16 v[250:251], v2 offset:37376
    v_rcp_f32 v14, v14
    v_mul_f32 v15, v113, v10
    v_mul_f32 v112, v112, v14
    v_mfma_f32_32x32x16_bf16 v[48:63], v[252:255], v[204:207], v[48:63]
    s_waitcnt lgkmcnt(2)
    ds_read_b64_tr_b16 v[252:253], v3 offset:36864
    ds_read_b64_tr_b16 v[254:255], v3 offset:37376
    v_exp_f32 v15, v15
    v_mul_f32 v113, v113, v121
    v_fma_f32 v15, v15, v9, v9
    v_mfma_f32_32x32x16_bf16 v[32:47], v[240:243], v[208:211], v[32:47]
    ds_read_b64_tr_b16 v[240:241], v2 offset:40960
    ds_read_b64_tr_b16 v[242:243], v2 offset:41472
    v_rcp_f32 v15, v15
    v_mul_f32 v16, v114, v10
    v_mul_f32 v113, v113, v15
    v_mfma_f32_32x32x16_bf16 v[48:63], v[244:247], v[208:211], v[48:63]
    s_waitcnt lgkmcnt(2)
    ds_read_b64_tr_b16 v[244:245], v3 offset:40960
    ds_read_b64_tr_b16 v[246:247], v3 offset:41472
    v_cvt_pk_bf16_f32 v120, v112, v113
    v_exp_f32 v16, v16
    v_mul_f32 v114, v114, v122
    v_mfma_f32_32x32x16_bf16 v[32:47], v[248:251], v[212:215], v[32:47]
    ds_read_b64_tr_b16 v[248:249], v2 offset:45056
    ds_read_b64_tr_b16 v[250:251], v2 offset:45568
    v_fma_f32 v16, v16, v9, v9
    v_rcp_f32 v16, v16
    v_mul_f32 v14, v115, v10
    v_mfma_f32_32x32x16_bf16 v[48:63], v[252:255], v[212:215], v[48:63]
    s_waitcnt lgkmcnt(2)
    ds_read_b64_tr_b16 v[252:253], v3 offset:45056
    ds_read_b64_tr_b16 v[254:255], v3 offset:45568
    v_mul_f32 v114, v114, v16
    v_exp_f32 v14, v14
    v_add_u32 v2, 0xfffe4000, v2
    v_mfma_f32_32x32x16_bf16 v[32:47], v[240:243], v[216:219], v[32:47]
    s_barrier
    ds_read_b64_tr_b16 v[240:241], v2 offset:0
    ds_read_b64_tr_b16 v[242:243], v2 offset:512
    v_mul_f32 v115, v115, v123
    v_fma_f32 v14, v14, v9, v9
    v_add_u32 v3, 0xfffe4000, v3
    v_mfma_f32_32x32x16_bf16 v[48:63], v[244:247], v[216:219], v[48:63]
    s_waitcnt lgkmcnt(2)
    ds_read_b64_tr_b16 v[244:245], v3 offset:0
    ds_read_b64_tr_b16 v[246:247], v3 offset:512
    v_rcp_f32 v14, v14
    v_mul_f32 v15, v116, v10
    v_mul_f32 v115, v115, v14
    v_mfma_f32_32x32x16_bf16 v[32:47], v[248:251], v[220:223], v[32:47]
    ds_read_b64_tr_b16 v[248:249], v2 offset:4096
    ds_read_b64_tr_b16 v[250:251], v2 offset:4608
    v_cvt_pk_bf16_f32 v121, v114, v115
    v_exp_f32 v15, v15
    v_mul_f32 v116, v116, v124
    v_mfma_f32_32x32x16_bf16 v[48:63], v[252:255], v[220:223], v[48:63]
    s_waitcnt lgkmcnt(2)
    ds_read_b64_tr_b16 v[252:253], v3 offset:4096
    ds_read_b64_tr_b16 v[254:255], v3 offset:4608
    v_fma_f32 v15, v15, v9, v9
    v_rcp_f32 v15, v15
    v_mul_f32 v16, v117, v10
    v_mfma_f32_32x32x16_bf16 v[32:47], v[240:243], v[224:227], v[32:47]
    ds_read_b64_tr_b16 v[240:241], v2 offset:8192
    ds_read_b64_tr_b16 v[242:243], v2 offset:8704
    v_mul_f32 v116, v116, v15
    v_exp_f32 v16, v16
    v_mul_f32 v117, v117, v125
    v_mfma_f32_32x32x16_bf16 v[48:63], v[244:247], v[224:227], v[48:63]
    s_waitcnt lgkmcnt(2)
    ds_read_b64_tr_b16 v[244:245], v3 offset:8192
    ds_read_b64_tr_b16 v[246:247], v3 offset:8704
    v_fma_f32 v16, v16, v9, v9
    v_rcp_f32 v16, v16
    v_mul_f32 v14, v118, v10
    v_mfma_f32_32x32x16_bf16 v[32:47], v[248:251], v[228:231], v[32:47]
    ds_read_b64_tr_b16 v[248:249], v2 offset:12288
    ds_read_b64_tr_b16 v[250:251], v2 offset:12800
    v_mul_f32 v117, v117, v16
    v_cvt_pk_bf16_f32 v122, v116, v117
    v_exp_f32 v14, v14
    v_mfma_f32_32x32x16_bf16 v[48:63], v[252:255], v[228:231], v[48:63]
    s_waitcnt lgkmcnt(2)
    ds_read_b64_tr_b16 v[252:253], v3 offset:12288
    ds_read_b64_tr_b16 v[254:255], v3 offset:12800
    v_mul_f32 v118, v118, v126
    v_fma_f32 v14, v14, v9, v9
    v_add_u32 v4, 0x10000, v4
    v_mfma_f32_32x32x16_bf16 v[32:47], v[240:243], v[232:235], v[32:47]
    ds_read_b64_tr_b16 v[240:241], v4 offset:0
    ds_read_b64_tr_b16 v[242:243], v4 offset:512
    v_rcp_f32 v14, v14
    v_mul_f32 v15, v119, v10
    v_add_u32 v5, 0x10000, v5
    v_mfma_f32_32x32x16_bf16 v[48:63], v[244:247], v[232:235], v[48:63]
    s_waitcnt lgkmcnt(2)
    ds_read_b64_tr_b16 v[244:245], v5 offset:0
    ds_read_b64_tr_b16 v[246:247], v5 offset:512
    v_mul_f32 v118, v118, v14
    v_exp_f32 v15, v15
    v_mul_f32 v119, v119, v127
    v_mfma_f32_32x32x16_bf16 v[32:47], v[248:251], v[236:239], v[32:47]
    ds_read_b64_tr_b16 v[248:249], v4 offset:4096
    ds_read_b64_tr_b16 v[250:251], v4 offset:4608
    v_fma_f32 v15, v15, v9, v9
    v_rcp_f32 v15, v15
    s_nop 0
    v_mul_f32 v119, v119, v15
    v_mfma_f32_32x32x16_bf16 v[48:63], v[252:255], v[236:239], v[48:63]
    s_waitcnt lgkmcnt(2)
    ds_read_b64_tr_b16 v[252:253], v5 offset:4096
    ds_read_b64_tr_b16 v[254:255], v5 offset:4608
    v_cvt_pk_bf16_f32 v123, v118, v119
    v_mul_f32 v14, v96, v10
    v_exp_f32 v14, v14
    v_mfma_f32_32x32x16_bf16 v[64:79], v[240:243], v[128:131], 0
    ds_read_b64_tr_b16 v[240:241], v4 offset:8192
    ds_read_b64_tr_b16 v[242:243], v4 offset:8704
    v_mul_f32 v96, v96, v104
    v_fma_f32 v14, v14, v9, v9
    v_rcp_f32 v14, v14
    v_mfma_f32_32x32x16_bf16 v[80:95], v[244:247], v[128:131], 0
    s_waitcnt lgkmcnt(2)
    ds_read_b64_tr_b16 v[244:245], v5 offset:8192
    ds_read_b64_tr_b16 v[246:247], v5 offset:8704
    v_mul_f32 v15, v97, v10
    v_mul_f32 v96, v96, v14
    v_exp_f32 v15, v15
    v_mfma_f32_32x32x16_bf16 v[64:79], v[248:251], v[132:135], v[64:79]
    ds_read_b64_tr_b16 v[248:249], v4 offset:12288
    ds_read_b64_tr_b16 v[250:251], v4 offset:12800
    v_mul_f32 v97, v97, v105
    v_fma_f32 v15, v15, v9, v9
    v_rcp_f32 v15, v15
    v_mfma_f32_32x32x16_bf16 v[80:95], v[252:255], v[132:135], v[80:95]
    s_waitcnt lgkmcnt(2)
    ds_read_b64_tr_b16 v[252:253], v5 offset:12288
    ds_read_b64_tr_b16 v[254:255], v5 offset:12800
    v_mul_f32 v16, v98, v10
    v_mul_f32 v97, v97, v15
    v_cvt_pk_bf16_f32 v112, v96, v97
    v_mfma_f32_32x32x16_bf16 v[64:79], v[240:243], v[136:139], v[64:79]
    ds_read_b64_tr_b16 v[240:241], v4 offset:16384
    ds_read_b64_tr_b16 v[242:243], v4 offset:16896
    v_exp_f32 v16, v16
    v_mul_f32 v98, v98, v106
    v_fma_f32 v16, v16, v9, v9
    v_mfma_f32_32x32x16_bf16 v[80:95], v[244:247], v[136:139], v[80:95]
    s_waitcnt lgkmcnt(2)
    ds_read_b64_tr_b16 v[244:245], v5 offset:16384
    ds_read_b64_tr_b16 v[246:247], v5 offset:16896
    v_rcp_f32 v16, v16
    v_mul_f32 v14, v99, v10
    v_mul_f32 v98, v98, v16
    v_mfma_f32_32x32x16_bf16 v[64:79], v[248:251], v[140:143], v[64:79]
    ds_read_b64_tr_b16 v[248:249], v4 offset:20480
    ds_read_b64_tr_b16 v[250:251], v4 offset:20992
    v_exp_f32 v14, v14
    v_mul_f32 v99, v99, v107
    v_fma_f32 v14, v14, v9, v9
    v_mfma_f32_32x32x16_bf16 v[80:95], v[252:255], v[140:143], v[80:95]
    s_waitcnt lgkmcnt(2)
    ds_read_b64_tr_b16 v[252:253], v5 offset:20480
    ds_read_b64_tr_b16 v[254:255], v5 offset:20992
    v_rcp_f32 v14, v14
    v_mul_f32 v15, v100, v10
    v_mul_f32 v99, v99, v14
    v_mfma_f32_32x32x16_bf16 v[64:79], v[240:243], v[144:147], v[64:79]
    ds_read_b64_tr_b16 v[240:241], v4 offset:24576
    ds_read_b64_tr_b16 v[242:243], v4 offset:25088
    v_cvt_pk_bf16_f32 v113, v98, v99
    v_exp_f32 v15, v15
    v_mul_f32 v100, v100, v108
    v_mfma_f32_32x32x16_bf16 v[80:95], v[244:247], v[144:147], v[80:95]
    s_waitcnt lgkmcnt(2)
    ds_read_b64_tr_b16 v[244:245], v5 offset:24576
    ds_read_b64_tr_b16 v[246:247], v5 offset:25088
    v_fma_f32 v15, v15, v9, v9
    v_rcp_f32 v15, v15
    v_mul_f32 v16, v101, v10
    v_mfma_f32_32x32x16_bf16 v[64:79], v[248:251], v[148:151], v[64:79]
    ds_read_b64_tr_b16 v[248:249], v4 offset:28672
    ds_read_b64_tr_b16 v[250:251], v4 offset:29184
    v_mul_f32 v100, v100, v15
    v_exp_f32 v16, v16
    v_mul_f32 v101, v101, v109
    v_mfma_f32_32x32x16_bf16 v[80:95], v[252:255], v[148:151], v[80:95]
    s_waitcnt lgkmcnt(2)
    ds_read_b64_tr_b16 v[252:253], v5 offset:28672
    ds_read_b64_tr_b16 v[254:255], v5 offset:29184
    v_fma_f32 v16, v16, v9, v9
    v_rcp_f32 v16, v16
    v_mul_f32 v14, v102, v10
    v_mfma_f32_32x32x16_bf16 v[64:79], v[240:243], v[152:155], v[64:79]
    ds_read_b64_tr_b16 v[240:241], v4 offset:32768
    ds_read_b64_tr_b16 v[242:243], v4 offset:33280
    v_mul_f32 v101, v101, v16
    v_cvt_pk_bf16_f32 v114, v100, v101
    v_exp_f32 v14, v14
    v_mfma_f32_32x32x16_bf16 v[80:95], v[244:247], v[152:155], v[80:95]
    s_waitcnt lgkmcnt(2)
    ds_read_b64_tr_b16 v[244:245], v5 offset:32768
    ds_read_b64_tr_b16 v[246:247], v5 offset:33280
    v_mul_f32 v102, v102, v110
    v_fma_f32 v14, v14, v9, v9
    v_rcp_f32 v14, v14
    v_mfma_f32_32x32x16_bf16 v[64:79], v[248:251], v[156:159], v[64:79]
    ds_read_b64_tr_b16 v[248:249], v4 offset:36864
    ds_read_b64_tr_b16 v[250:251], v4 offset:37376
    v_mul_f32 v15, v103, v10
    v_mul_f32 v102, v102, v14
    v_exp_f32 v15, v15
    v_mfma_f32_32x32x16_bf16 v[80:95], v[252:255], v[156:159], v[80:95]
    s_waitcnt lgkmcnt(2)
    ds_read_b64_tr_b16 v[252:253], v5 offset:36864
    ds_read_b64_tr_b16 v[254:255], v5 offset:37376
    v_mul_f32 v103, v103, v111
    v_fma_f32 v15, v15, v9, v9
    v_rcp_f32 v15, v15
    v_mfma_f32_32x32x16_bf16 v[64:79], v[240:243], v[160:163], v[64:79]
    ds_read_b64_tr_b16 v[240:241], v4 offset:40960
    ds_read_b64_tr_b16 v[242:243], v4 offset:41472
    v_mul_f32 v103, v103, v15
    v_cvt_pk_bf16_f32 v115, v102, v103
    v_mul_f32 v14, v32, v10
    v_mfma_f32_32x32x16_bf16 v[80:95], v[244:247], v[160:163], v[80:95]
    s_waitcnt lgkmcnt(2)
    ds_read_b64_tr_b16 v[244:245], v5 offset:40960
    ds_read_b64_tr_b16 v[246:247], v5 offset:41472
    v_exp_f32 v14, v14
    v_mul_f32 v32, v32, v40
    v_fma_f32 v14, v14, v9, v9
    v_mfma_f32_32x32x16_bf16 v[64:79], v[248:251], v[164:167], v[64:79]
    ds_read_b64_tr_b16 v[248:249], v4 offset:45056
    ds_read_b64_tr_b16 v[250:251], v4 offset:45568
    v_rcp_f32 v14, v14
    v_mul_f32 v15, v33, v10
    v_mul_f32 v32, v32, v14
    v_mfma_f32_32x32x16_bf16 v[80:95], v[252:255], v[164:167], v[80:95]
    s_waitcnt lgkmcnt(2)
    ds_read_b64_tr_b16 v[252:253], v5 offset:45056
    ds_read_b64_tr_b16 v[254:255], v5 offset:45568
    v_exp_f32 v15, v15
    v_mul_f32 v33, v33, v41
    v_mfma_f32_32x32x16_bf16 v[64:79], v[240:243], v[168:171], v[64:79]
    ds_read_b64_tr_b16 v[240:241], v4 offset:49152
    ds_read_b64_tr_b16 v[242:243], v4 offset:49664
    v_fma_f32 v15, v15, v9, v9
    v_rcp_f32 v15, v15
    v_mul_f32 v16, v34, v10
    v_mfma_f32_32x32x16_bf16 v[80:95], v[244:247], v[168:171], v[80:95]
    s_waitcnt lgkmcnt(2)
    ds_read_b64_tr_b16 v[244:245], v5 offset:49152
    ds_read_b64_tr_b16 v[246:247], v5 offset:49664
    v_mul_f32 v33, v33, v15
    v_cvt_pk_bf16_f32 v40, v32, v33
    v_exp_f32 v16, v16
    v_mfma_f32_32x32x16_bf16 v[64:79], v[248:251], v[172:175], v[64:79]
    ds_read_b64_tr_b16 v[248:249], v4 offset:53248
    ds_read_b64_tr_b16 v[250:251], v4 offset:53760
    v_mul_f32 v34, v34, v42
    v_fma_f32 v16, v16, v9, v9
    v_rcp_f32 v16, v16
    v_mfma_f32_32x32x16_bf16 v[80:95], v[252:255], v[172:175], v[80:95]
    s_waitcnt lgkmcnt(2)
    ds_read_b64_tr_b16 v[252:253], v5 offset:53248
    ds_read_b64_tr_b16 v[254:255], v5 offset:53760
    v_mul_f32 v14, v35, v10
    v_mul_f32 v34, v34, v16
    v_exp_f32 v14, v14
    v_mfma_f32_32x32x16_bf16 v[64:79], v[240:243], v[176:179], v[64:79]
    ds_read_b64_tr_b16 v[240:241], v4 offset:57344
    ds_read_b64_tr_b16 v[242:243], v4 offset:57856
    v_mul_f32 v35, v35, v43
    v_fma_f32 v14, v14, v9, v9
    v_rcp_f32 v14, v14
    v_mfma_f32_32x32x16_bf16 v[80:95], v[244:247], v[176:179], v[80:95]
    s_waitcnt lgkmcnt(2)
    ds_read_b64_tr_b16 v[244:245], v5 offset:57344
    ds_read_b64_tr_b16 v[246:247], v5 offset:57856
    v_mul_f32 v15, v36, v10
    v_mul_f32 v35, v35, v14
    v_cvt_pk_bf16_f32 v41, v34, v35
    v_mfma_f32_32x32x16_bf16 v[64:79], v[248:251], v[180:183], v[64:79]
    ds_read_b64_tr_b16 v[248:249], v4 offset:61440
    ds_read_b64_tr_b16 v[250:251], v4 offset:61952
    v_exp_f32 v15, v15
    v_mul_f32 v36, v36, v44
    v_mfma_f32_32x32x16_bf16 v[80:95], v[252:255], v[180:183], v[80:95]
    s_waitcnt lgkmcnt(2)
    ds_read_b64_tr_b16 v[252:253], v5 offset:61440
    ds_read_b64_tr_b16 v[254:255], v5 offset:61952
    v_fma_f32 v15, v15, v9, v9
    v_rcp_f32 v15, v15
    v_add_u32 v4, 0xc000, v4
    v_mfma_f32_32x32x16_bf16 v[64:79], v[240:243], v[184:187], v[64:79]
    ds_read_b64_tr_b16 v[240:241], v4 offset:16384
    ds_read_b64_tr_b16 v[242:243], v4 offset:16896
    v_mul_f32 v16, v37, v10
    v_mul_f32 v36, v36, v15
    v_add_u32 v5, 0xc000, v5
    v_mfma_f32_32x32x16_bf16 v[80:95], v[244:247], v[184:187], v[80:95]
    s_waitcnt lgkmcnt(2)
    ds_read_b64_tr_b16 v[244:245], v5 offset:16384
    ds_read_b64_tr_b16 v[246:247], v5 offset:16896
    v_exp_f32 v16, v16
    v_mul_f32 v37, v37, v45
    v_fma_f32 v16, v16, v9, v9
    v_mfma_f32_32x32x16_bf16 v[64:79], v[248:251], v[188:191], v[64:79]
    ds_read_b64_tr_b16 v[248:249], v4 offset:20480
    ds_read_b64_tr_b16 v[250:251], v4 offset:20992
    v_rcp_f32 v16, v16
    v_mul_f32 v14, v38, v10
    v_mul_f32 v37, v37, v16
    v_mfma_f32_32x32x16_bf16 v[80:95], v[252:255], v[188:191], v[80:95]
    s_waitcnt lgkmcnt(2)
    ds_read_b64_tr_b16 v[252:253], v5 offset:20480
    ds_read_b64_tr_b16 v[254:255], v5 offset:20992
    v_cvt_pk_bf16_f32 v42, v36, v37
    v_exp_f32 v14, v14
    v_mul_f32 v38, v38, v46
    v_mfma_f32_32x32x16_bf16 v[64:79], v[240:243], v[192:195], v[64:79]
    ds_read_b64_tr_b16 v[240:241], v4 offset:24576
    ds_read_b64_tr_b16 v[242:243], v4 offset:25088
    v_fma_f32 v14, v14, v9, v9
    v_rcp_f32 v14, v14
    v_mul_f32 v15, v39, v10
    v_mfma_f32_32x32x16_bf16 v[80:95], v[244:247], v[192:195], v[80:95]
    s_waitcnt lgkmcnt(2)
    ds_read_b64_tr_b16 v[244:245], v5 offset:24576
    ds_read_b64_tr_b16 v[246:247], v5 offset:25088
    v_mul_f32 v38, v38, v14
    v_exp_f32 v15, v15
    v_mul_f32 v39, v39, v47
    v_mfma_f32_32x32x16_bf16 v[64:79], v[248:251], v[196:199], v[64:79]
    ds_read_b64_tr_b16 v[248:249], v4 offset:28672
    ds_read_b64_tr_b16 v[250:251], v4 offset:29184
    v_fma_f32 v15, v15, v9, v9
    v_rcp_f32 v15, v15
    s_nop 0
    v_mul_f32 v39, v39, v15
    v_mfma_f32_32x32x16_bf16 v[80:95], v[252:255], v[196:199], v[80:95]
    s_waitcnt lgkmcnt(2)
    ds_read_b64_tr_b16 v[252:253], v5 offset:28672
    ds_read_b64_tr_b16 v[254:255], v5 offset:29184
    v_cvt_pk_bf16_f32 v43, v38, v39
    v_mul_f32 v14, v48, v10
    v_exp_f32 v14, v14
    v_mfma_f32_32x32x16_bf16 v[64:79], v[240:243], v[200:203], v[64:79]
    ds_read_b64_tr_b16 v[240:241], v4 offset:32768
    ds_read_b64_tr_b16 v[242:243], v4 offset:33280
    v_mul_f32 v48, v48, v56
    v_fma_f32 v14, v14, v9, v9
    v_rcp_f32 v14, v14
    v_mfma_f32_32x32x16_bf16 v[80:95], v[244:247], v[200:203], v[80:95]
    s_waitcnt lgkmcnt(2)
    ds_read_b64_tr_b16 v[244:245], v5 offset:32768
    ds_read_b64_tr_b16 v[246:247], v5 offset:33280
    v_mul_f32 v15, v49, v10
    v_mul_f32 v48, v48, v14
    v_exp_f32 v15, v15
    v_mfma_f32_32x32x16_bf16 v[64:79], v[248:251], v[204:207], v[64:79]
    ds_read_b64_tr_b16 v[248:249], v4 offset:36864
    ds_read_b64_tr_b16 v[250:251], v4 offset:37376
    v_mul_f32 v49, v49, v57
    v_fma_f32 v15, v15, v9, v9
    v_rcp_f32 v15, v15
    v_mfma_f32_32x32x16_bf16 v[80:95], v[252:255], v[204:207], v[80:95]
    s_waitcnt lgkmcnt(2)
    ds_read_b64_tr_b16 v[252:253], v5 offset:36864
    ds_read_b64_tr_b16 v[254:255], v5 offset:37376
    v_mul_f32 v16, v50, v10
    v_mul_f32 v49, v49, v15
    v_cvt_pk_bf16_f32 v56, v48, v49
    v_mfma_f32_32x32x16_bf16 v[64:79], v[240:243], v[208:211], v[64:79]
    ds_read_b64_tr_b16 v[240:241], v4 offset:40960
    ds_read_b64_tr_b16 v[242:243], v4 offset:41472
    v_exp_f32 v16, v16
    v_mul_f32 v50, v50, v58
    v_fma_f32 v16, v16, v9, v9
    v_mfma_f32_32x32x16_bf16 v[80:95], v[244:247], v[208:211], v[80:95]
    s_waitcnt lgkmcnt(2)
    ds_read_b64_tr_b16 v[244:245], v5 offset:40960
    ds_read_b64_tr_b16 v[246:247], v5 offset:41472
    v_rcp_f32 v16, v16
    v_mul_f32 v14, v51, v10
    v_mul_f32 v50, v50, v16
    v_mfma_f32_32x32x16_bf16 v[64:79], v[248:251], v[212:215], v[64:79]
    ds_read_b64_tr_b16 v[248:249], v4 offset:45056
    ds_read_b64_tr_b16 v[250:251], v4 offset:45568
    v_exp_f32 v14, v14
    v_mul_f32 v51, v51, v59
    v_fma_f32 v14, v14, v9, v9
    v_mfma_f32_32x32x16_bf16 v[80:95], v[252:255], v[212:215], v[80:95]
    s_waitcnt lgkmcnt(2)
    ds_read_b64_tr_b16 v[252:253], v5 offset:45056
    ds_read_b64_tr_b16 v[254:255], v5 offset:45568
    v_rcp_f32 v14, v14
    v_mul_f32 v15, v52, v10
    v_add_u32 v4, 0xfffe4000, v4
    v_mfma_f32_32x32x16_bf16 v[64:79], v[240:243], v[216:219], v[64:79]
    ds_read_b64_tr_b16 v[240:241], v4 offset:0
    ds_read_b64_tr_b16 v[242:243], v4 offset:512
    v_mul_f32 v51, v51, v14
    v_cvt_pk_bf16_f32 v57, v50, v51
    v_add_u32 v5, 0xfffe4000, v5
    v_mfma_f32_32x32x16_bf16 v[80:95], v[244:247], v[216:219], v[80:95]
    s_waitcnt lgkmcnt(2)
    ds_read_b64_tr_b16 v[244:245], v5 offset:0
    ds_read_b64_tr_b16 v[246:247], v5 offset:512
    v_exp_f32 v15, v15
    v_mul_f32 v52, v52, v60
    v_fma_f32 v15, v15, v9, v9
    v_mfma_f32_32x32x16_bf16 v[64:79], v[248:251], v[220:223], v[64:79]
    ds_read_b64_tr_b16 v[248:249], v4 offset:4096
    ds_read_b64_tr_b16 v[250:251], v4 offset:4608
    v_rcp_f32 v15, v15
    v_mul_f32 v16, v53, v10
    v_mul_f32 v52, v52, v15
    v_mfma_f32_32x32x16_bf16 v[80:95], v[252:255], v[220:223], v[80:95]
    s_waitcnt lgkmcnt(2)
    ds_read_b64_tr_b16 v[252:253], v5 offset:4096
    ds_read_b64_tr_b16 v[254:255], v5 offset:4608
    v_exp_f32 v16, v16
    v_mul_f32 v53, v53, v61
    v_fma_f32 v16, v16, v9, v9
    v_mfma_f32_32x32x16_bf16 v[64:79], v[240:243], v[224:227], v[64:79]
    ds_read_b64_tr_b16 v[240:241], v4 offset:8192
    ds_read_b64_tr_b16 v[242:243], v4 offset:8704
    v_rcp_f32 v16, v16
    v_mul_f32 v14, v54, v10
    v_mul_f32 v53, v53, v16
    v_mfma_f32_32x32x16_bf16 v[80:95], v[244:247], v[224:227], v[80:95]
    s_waitcnt lgkmcnt(2)
    ds_read_b64_tr_b16 v[244:245], v5 offset:8192
    ds_read_b64_tr_b16 v[246:247], v5 offset:8704
    v_cvt_pk_bf16_f32 v58, v52, v53
    v_exp_f32 v14, v14
    v_mul_f32 v54, v54, v62
    v_mfma_f32_32x32x16_bf16 v[64:79], v[248:251], v[228:231], v[64:79]
    ds_read_b64_tr_b16 v[248:249], v4 offset:12288
    ds_read_b64_tr_b16 v[250:251], v4 offset:12800
    v_fma_f32 v14, v14, v9, v9
    v_rcp_f32 v14, v14
    v_mul_f32 v15, v55, v10
    v_mfma_f32_32x32x16_bf16 v[80:95], v[252:255], v[228:231], v[80:95]
    s_waitcnt lgkmcnt(2)
    ds_read_b64_tr_b16 v[252:253], v5 offset:12288
    ds_read_b64_tr_b16 v[254:255], v5 offset:12800
    v_mul_f32 v54, v54, v14
    v_exp_f32 v15, v15
    v_mul_f32 v55, v55, v63
    v_mfma_f32_32x32x16_bf16 v[64:79], v[240:243], v[232:235], v[64:79]
    ds_read_b64_tr_b16 v[240:241], v28 offset:0
    ds_read_b64_tr_b16 v[242:243], v28 offset:256
    v_fma_f32 v15, v15, v9, v9
    v_rcp_f32 v15, v15
    s_nop 0
    v_mul_f32 v55, v55, v15
    v_mfma_f32_32x32x16_bf16 v[80:95], v[244:247], v[232:235], v[80:95]
    s_waitcnt lgkmcnt(2)
    ds_read_b64_tr_b16 v[244:245], v28 offset:1024
    ds_read_b64_tr_b16 v[246:247], v28 offset:1280
    v_cvt_pk_bf16_f32 v59, v54, v55
    v_mfma_f32_32x32x16_bf16 v[64:79], v[248:251], v[236:239], v[64:79]
    ds_read_b64_tr_b16 v[248:249], v28 offset:2048
    ds_read_b64_tr_b16 v[250:251], v28 offset:2304
    v_mfma_f32_32x32x16_bf16 v[80:95], v[252:255], v[236:239], v[80:95]
    s_waitcnt lgkmcnt(2)
    ds_read_b64_tr_b16 v[252:253], v28 offset:3072
    ds_read_b64_tr_b16 v[254:255], v28 offset:3328
L_qpass:
    v_mfma_f32_32x32x16_bf16 v[96:111], v[240:243], v[128:131], 0
    buffer_store_dwordx4 v[20:23], v29, s[60:63], s6 offen sc1
    ds_read_b64_tr_b16 v[240:241], v28 offset:4096
    ds_read_b64_tr_b16 v[242:243], v28 offset:4352
    v_mfma_f32_32x32x16_bf16 v[96:111], v[244:247], v[132:135], v[96:111]
    s_waitcnt lgkmcnt(2)
    ds_read_b64_tr_b16 v[244:245], v28 offset:5120
    ds_read_b64_tr_b16 v[246:247], v28 offset:5376
    v_mfma_f32_32x32x16_bf16 v[96:111], v[248:251], v[136:139], v[96:111]
    buffer_store_dwordx4 v[24:27], v29, s[60:63], s7 offen sc1
    ds_read_b64_tr_b16 v[248:249], v28 offset:6144
    ds_read_b64_tr_b16 v[250:251], v28 offset:6400
    v_mfma_f32_32x32x16_bf16 v[96:111], v[252:255], v[140:143], v[96:111]
    s_waitcnt lgkmcnt(2)
    ds_read_b64_tr_b16 v[252:253], v28 offset:7168
    ds_read_b64_tr_b16 v[254:255], v28 offset:7424
    v_mul_f32 v14, v64, v10
    v_exp_f32 v14, v14
    v_mul_f32 v64, v64, v72
    v_fma_f32 v14, v14, v9, v9
    v_mfma_f32_32x32x16_bf16 v[96:111], v[240:243], v[144:147], v[96:111]
    buffer_store_dwordx4 v[120:123], v29, s[60:63], s15 offen sc1
    ds_read_b64_tr_b16 v[240:241], v28 offset:8192
    ds_read_b64_tr_b16 v[242:243], v28 offset:8448
    v_rcp_f32 v14, v14
    v_mul_f32 v15, v65, v10
    v_mul_f32 v64, v64, v14
    v_exp_f32 v15, v15
    v_mfma_f32_32x32x16_bf16 v[96:111], v[244:247], v[148:151], v[96:111]
    s_waitcnt lgkmcnt(2)
    ds_read_b64_tr_b16 v[244:245], v28 offset:9216
    ds_read_b64_tr_b16 v[246:247], v28 offset:9472
    v_mul_f32 v65, v65, v73
    v_fma_f32 v15, v15, v9, v9
    v_rcp_f32 v15, v15
    v_mul_f32 v16, v66, v10
    v_mul_f32 v65, v65, v15
    v_mfma_f32_32x32x16_bf16 v[96:111], v[248:251], v[152:155], v[96:111]
    buffer_store_dwordx4 v[112:115], v29, s[60:63], s14 offen sc1
    ds_read_b64_tr_b16 v[248:249], v28 offset:10240
    ds_read_b64_tr_b16 v[250:251], v28 offset:10496
    v_cvt_pk_bf16_f32 v72, v64, v65
    v_exp_f32 v16, v16
    v_mul_f32 v66, v66, v74
    v_fma_f32 v16, v16, v9, v9
    v_mfma_f32_32x32x16_bf16 v[96:111], v[252:255], v[156:159], v[96:111]
    s_waitcnt lgkmcnt(2)
    ds_read_b64_tr_b16 v[252:253], v28 offset:11264
    ds_read_b64_tr_b16 v[254:255], v28 offset:11520
    v_rcp_f32 v16, v16
    v_mul_f32 v14, v67, v10
    v_mul_f32 v66, v66, v16
    v_exp_f32 v14, v14
    v_mfma_f32_32x32x16_bf16 v[96:111], v[240:243], v[160:163], v[96:111]
    buffer_store_dwordx4 v[40:43], v29, s[60:63], s16 offen sc1
    ds_read_b64_tr_b16 v[240:241], v28 offset:12288
    ds_read_b64_tr_b16 v[242:243], v28 offset:12544
    v_mul_f32 v67, v67, v75
    v_fma_f32 v14, v14, v9, v9
    v_rcp_f32 v14, v14
    v_mul_f32 v15, v68, v10
    v_mul_f32 v67, v67, v14
    v_mfma_f32_32x32x16_bf16 v[96:111], v[244:247], v[164:167], v[96:111]
    s_waitcnt lgkmcnt(2)
    ds_read_b64_tr_b16 v[244:245], v28 offset:13312
    ds_read_b64_tr_b16 v[246:247], v28 offset:13568
    v_cvt_pk_bf16_f32 v73, v66, v67
    v_exp_f32 v15, v15
    v_mul_f32 v68, v68, v76
    v_fma_f32 v15, v15, v9, v9
    v_mfma_f32_32x32x16_bf16 v[96:111], v[248:251], v[168:171], v[96:111]
    buffer_store_dwordx4 v[56:59], v29, s[60:63], s17 offen sc1
    ds_read_b64_tr_b16 v[248:249], v28 offset:14336
    ds_read_b64_tr_b16 v[250:251], v28 offset:14592
    v_rcp_f32 v15, v15
    v_mul_f32 v16, v69, v10
    v_mul_f32 v68, v68, v15
    v_exp_f32 v16, v16
    v_mfma_f32_32x32x16_bf16 v[96:111], v[252:255], v[172:175], v[96:111]
    s_waitcnt lgkmcnt(2)
    ds_read_b64_tr_b16 v[252:253], v28 offset:15360
    ds_read_b64_tr_b16 v[254:255], v28 offset:15616
    v_mul_f32 v69, v69, v77
    v_fma_f32 v16, v16, v9, v9
    v_rcp_f32 v16, v16
    v_mul_f32 v14, v70, v10
    v_mul_f32 v69, v69, v16
    v_mfma_f32_32x32x16_bf16 v[96:111], v[240:243], v[176:179], v[96:111]
    ds_read_b64_tr_b16 v[240:241], v28 offset:16384
    ds_read_b64_tr_b16 v[242:243], v28 offset:16640
    v_cvt_pk_bf16_f32 v74, v68, v69
    v_exp_f32 v14, v14
    v_mul_f32 v70, v70, v78
    v_fma_f32 v14, v14, v9, v9
    v_mfma_f32_32x32x16_bf16 v[96:111], v[244:247], v[180:183], v[96:111]
    s_waitcnt lgkmcnt(2)
    ds_read_b64_tr_b16 v[244:245], v28 offset:17408
    ds_read_b64_tr_b16 v[246:247], v28 offset:17664
    v_rcp_f32 v14, v14
    v_mul_f32 v15, v71, v10
    v_mul_f32 v70, v70, v14
    v_exp_f32 v15, v15
    v_mfma_f32_32x32x16_bf16 v[96:111], v[248:251], v[184:187], v[96:111]
    ds_read_b64_tr_b16 v[248:249], v28 offset:18432
    ds_read_b64_tr_b16 v[250:251], v28 offset:18688
    v_mul_f32 v71, v71, v79
    v_fma_f32 v15, v15, v9, v9
    v_rcp_f32 v15, v15
    s_nop 0
    v_mul_f32 v71, v71, v15
    v_cvt_pk_bf16_f32 v75, v70, v71
    v_mfma_f32_32x32x16_bf16 v[96:111], v[252:255], v[188:191], v[96:111]
    s_waitcnt lgkmcnt(2)
    ds_read_b64_tr_b16 v[252:253], v28 offset:19456
    ds_read_b64_tr_b16 v[254:255], v28 offset:19712
    v_mul_f32 v14, v80, v10
    v_exp_f32 v14, v14
    v_mul_f32 v80, v80, v88
    v_fma_f32 v14, v14, v9, v9
    v_mfma_f32_32x32x16_bf16 v[96:111], v[240:243], v[192:195], v[96:111]
    buffer_store_dwordx4 v[72:75], v29, s[60:63], s18 offen sc1
    ds_read_b64_tr_b16 v[240:241], v28 offset:20480
    ds_read_b64_tr_b16 v[242:243], v28 offset:20736
    v_rcp_f32 v14, v14
    v_mul_f32 v15, v81, v10
    v_mul_f32 v80, v80, v14
    v_exp_f32 v15, v15
    v_mfma_f32_32x32x16_bf16 v[96:111], v[244:247], v[196:199], v[96:111]
    s_waitcnt lgkmcnt(2)
    ds_read_b64_tr_b16 v[244:245], v28 offset:21504
    ds_read_b64_tr_b16 v[246:247], v28 offset:21760
    v_mul_f32 v81, v81, v89
    v_fma_f32 v15, v15, v9, v9
    v_rcp_f32 v15, v15
    v_mul_f32 v16, v82, v10
    v_mul_f32 v81, v81, v15
    v_mfma_f32_32x32x16_bf16 v[96:111], v[248:251], v[200:203], v[96:111]
    ds_read_b64_tr_b16 v[248:249], v28 offset:22528
    ds_read_b64_tr_b16 v[250:251], v28 offset:22784
    v_cvt_pk_bf16_f32 v88, v80, v81
    v_exp_f32 v16, v16
    v_mul_f32 v82, v82, v90
    v_fma_f32 v16, v16, v9, v9
    v_mfma_f32_32x32x16_bf16 v[96:111], v[252:255], v[204:207], v[96:111]
    s_waitcnt lgkmcnt(2)
    ds_read_b64_tr_b16 v[252:253], v28 offset:23552
    ds_read_b64_tr_b16 v[254:255], v28 offset:23808
    v_rcp_f32 v16, v16
    v_mul_f32 v14, v83, v10
    v_mul_f32 v82, v82, v16
    v_exp_f32 v14, v14
    v_mfma_f32_32x32x16_bf16 v[96:111], v[240:243], v[208:211], v[96:111]
    ds_read_b64_tr_b16 v[240:241], v28 offset:24576
    ds_read_b64_tr_b16 v[242:243], v28 offset:24832
    v_mul_f32 v83, v83, v91
    v_fma_f32 v14, v14, v9, v9
    v_rcp_f32 v14, v14
    v_mul_f32 v15, v84, v10
    v_mul_f32 v83, v83, v14
    v_mfma_f32_32x32x16_bf16 v[96:111], v[244:247], v[212:215], v[96:111]
    s_waitcnt lgkmcnt(2)
    ds_read_b64_tr_b16 v[244:245], v28 offset:25600
    ds_read_b64_tr_b16 v[246:247], v28 offset:25856
    v_cvt_pk_bf16_f32 v89, v82, v83
    v_exp_f32 v15, v15
    v_mul_f32 v84, v84, v92
    v_fma_f32 v15, v15, v9, v9
    v_mfma_f32_32x32x16_bf16 v[96:111], v[248:251], v[216:219], v[96:111]
    ds_read_b64_tr_b16 v[248:249], v28 offset:26624
    ds_read_b64_tr_b16 v[250:251], v28 offset:26880
    v_rcp_f32 v15, v15
    v_mul_f32 v16, v85, v10
    v_mul_f32 v84, v84, v15
    v_exp_f32 v16, v16
    v_mfma_f32_32x32x16_bf16 v[96:111], v[252:255], v[220:223], v[96:111]
    s_waitcnt lgkmcnt(2)
    ds_read_b64_tr_b16 v[252:253], v28 offset:27648
    ds_read_b64_tr_b16 v[254:255], v28 offset:27904
    v_mul_f32 v85, v85, v93
    v_fma_f32 v16, v16, v9, v9
    v_rcp_f32 v16, v16
    v_mul_f32 v14, v86, v10
    v_mul_f32 v85, v85, v16
    v_mfma_f32_32x32x16_bf16 v[96:111], v[240:243], v[224:227], v[96:111]
    v_cvt_pk_bf16_f32 v90, v84, v85
    v_exp_f32 v14, v14
    v_mul_f32 v86, v86, v94
    v_fma_f32 v14, v14, v9, v9
    v_mfma_f32_32x32x16_bf16 v[96:111], v[244:247], v[228:231], v[96:111]
    s_waitcnt lgkmcnt(0)
    v_rcp_f32 v14, v14
    v_mul_f32 v15, v87, v10
    v_mul_f32 v86, v86, v14
    v_exp_f32 v15, v15
    v_mfma_f32_32x32x16_bf16 v[96:111], v[248:251], v[232:235], v[96:111]
    v_mul_f32 v87, v87, v95
    v_fma_f32 v15, v15, v9, v9
    v_rcp_f32 v15, v15
    s_nop 0
    v_mul_f32 v87, v87, v15
    v_cvt_pk_bf16_f32 v91, v86, v87
    v_mfma_f32_32x32x16_bf16 v[96:111], v[252:255], v[236:239], v[96:111]
    s_lshl_b32 s74, s67, 11
    s_add_u32 s74, s74, 49152
    v_add_u32 v6, s74, v29
    s_lshl_b32 s74, s67, 8
    v_lshl_add_u32 v7, v1, 2, s74
    v_mul_f32 v12, 0x3e8b97f6, v11
    v_cndmask_b32 v13, v12, 0, s[94:95]
    v_mov_b32 v14, 58368
    v_mov_b32 v15, 0
    ds_write_b32 v14, v15
    s_nop 1
    v_mul_f32 v96, v96, v12
    v_mul_f32 v97, v97, v12
    v_mul_f32 v98, v98, v12
    v_mul_f32 v99, v99, v12
    v_mul_f32 v100, v100, v12
    v_mul_f32 v101, v101, v12
    v_mul_f32 v102, v102, v12
    v_mul_f32 v103, v103, v12
    v_cvt_pk_bf16_f32 v32, v96, v97
    v_cvt_pk_bf16_f32 v33, v98, v99
    v_cvt_pk_bf16_f32 v34, v100, v101
    v_cvt_pk_bf16_f32 v35, v102, v103
    ds_write_b128 v6, v[32:35]
    v_mul_f32 v104, v104, v12
    v_mul_f32 v105, v105, v12
    v_mul_f32 v106, v106, v12
    v_mul_f32 v107, v107, v12
    v_mul_f32 v108, v108, v13
    v_mul_f32 v109, v109, v13
    v_mul_f32 v110, v110, v13
    v_mul_f32 v111, v111, v13
    v_cvt_pk_bf16_f32 v36, v104, v105
    v_cvt_pk_bf16_f32 v37, v106, v107
    v_cvt_pk_bf16_f32 v38, v108, v109
    v_cvt_pk_bf16_f32 v39, v110, v111
    ds_write_b128 v6, v[36:39] offset:1024
    s_waitcnt lgkmcnt(0)
    s_barrier
    v_mul_f32 v14, v96, v96
    v_mul_f32 v15, v97, v97
    v_fmac_f32 v14, v98, v98
    v_fmac_f32 v15, v99, v99
    v_fmac_f32 v14, v100, v100
    v_fmac_f32 v15, v101, v101
    v_fmac_f32 v14, v102, v102
    v_fmac_f32 v15, v103, v103
    v_fmac_f32 v14, v104, v104
    v_fmac_f32 v15, v105, v105
    v_fmac_f32 v14, v106, v106
    v_fmac_f32 v15, v107, v107
    v_fmac_f32 v14, v108, v108
    v_fmac_f32 v15, v109, v109
    v_fmac_f32 v14, v110, v110
    v_fmac_f32 v15, v111, v111
    v_add_f32 v14, v14, v15
    v_mov_b32 v15, v14
    s_nop 1
    v_permlane32_swap_b32 v14, v15
    v_add_f32 v14, v14, v15
    ds_write_b32 v7, v14 offset:57344
    s_waitcnt lgkmcnt(0)
    s_barrier
    s_cmp_eq_u32 s70, 7
    s_cbranch_scc1 L_fin
    s_setprio 1
    buffer_store_dwordx4 v[88:91], v29, s[60:63], s19 offen sc1
    s_lshl_b32 s74, s68, 14
    s_lshl_b32 s76, s67, 11
    s_add_u32 s75, s74, s76
    s_lshl_b32 s76, s69, 7
    s_add_u32 s75, s75, s76
    s_add_u32 s75, s75, 9961472
    v_mov_b32 v6, 0
    v_mov_b32 v7, 1
    s_mov_b64 exec, 1
    s_waitcnt vmcnt(0)
    buffer_store_dword v7, v6, s[40:43], s75 offen sc1
    s_mov_b64 exec, -1
    s_mov_b32 s44, s20
    s_mov_b32 s45, s21
    s_mov_b32 s46, 1605632
    s_mov_b32 s47, 0x20000
    s_mov_b32 s48, s12
    s_mov_b32 s49, s13
    s_mov_b32 s50, 401408
    s_mov_b32 s51, 0x20000
    v_bfe_u32 v6, v1, 2, 1
    v_and_b32 v7, 3, v1
    v_lshlrev_b32 v7, 7, v7
    v_lshl_add_u32 v7, v6, 11, v7
    s_lshl_b32 s75, s81, 12
    s_add_u32 s74, s74, s75
    s_add_u32 s74, s74, 9961472
    s_mul_i32 s75, s67, 3
    s_and_b32 s76, s67, 2
    s_add_u32 s75, s75, s76
    s_lshl_b32 s75, s75, 7
    s_add_u32 s75, s75, s74
    v_add_u32 v5, s75, v7
    s_lshl_b32 s75, s67, 9
    s_add_u32 s75, s75, s74
    v_add_u32 v28, s75, v7
    v_bfe_u32 v6, v1, 4, 1
    v_lshrrev_b32 v8, 3, v1
    v_and_b32 v9, 2, v8
    v_lshlrev_b32 v9, 1, v9
    v_and_b32 v10, 7, v1
    v_xor_b32 v9, v9, v10
    v_mul_u32_u24 v8, 896, v8
    v_lshl_add_u32 v8, v9, 4, v8
    s_lshl_b32 s75, s82, 7
    v_add_u32 v4, s75, v8
    s_mul_i32 s91, s67, 24576
    s_add_u32 s91, s91, 65536
    v_bfe_u32 v8, v1, 2, 2
    v_lshrrev_b32 v9, 5, v1
    v_lshl_add_u32 v9, v9, 2, v8
    v_lshlrev_b32 v9, 7, v9
    v_lshrrev_b32 v8, 1, v8
    v_lshl_add_u32 v9, v8, 6, v9
    v_lshl_add_u32 v9, v6, 5, v9
    v_and_b32 v8, 3, v1
    v_lshl_add_u32 v9, v8, 3, v9
    v_add_u32 v2, s91, v9
    v_xor_b32 v3, 64, v2
    s_mul_i32 s77, s67, 401408
    s_lshl_b32 s74, s68, 2
    s_lshl_b32 s75, s81, 1
    s_add_u32 s74, s74, s75
    s_mul_i32 s92, s74, 112
    s_mul_i32 s75, s67, 28
    s_add_u32 s92, s92, s75
    s_lshl_b32 s92, s92, 10
    s_add_u32 s92, s92, 2621440
    s_lshl_b32 s79, s74, 2
    s_add_u32 s79, s79, s67
    s_lshl_b32 s79, s79, 13
    s_add_u32 s79, s79, 524288
    s_mul_i32 s4, s93, 57344
    s_add_u32 s5, s4, 57344
    s_cmp_eq_u32 s5, 401408
    s_cselect_b32 s5, 0, s5
    s_add_u32 s6, s5, 57344
    s_cmp_eq_u32 s6, 401408
    s_cselect_b32 s6, 0, s6
    s_add_u32 s7, s6, 57344
    s_cmp_eq_u32 s7, 401408
    s_cselect_b32 s7, 0, s7
    s_add_u32 s8, s7, 57344
    s_cmp_eq_u32 s8, 401408
    s_cselect_b32 s8, 0, s8
    s_add_u32 s9, s8, 57344
    s_cmp_eq_u32 s9, 401408
    s_cselect_b32 s9, 0, s9
    s_add_u32 s10, s9, 57344
    s_cmp_eq_u32 s10, 401408
    s_cselect_b32 s10, 0, s10
    s_add_u32 s4, s4, s77
    s_add_u32 s5, s5, s77
    s_add_u32 s6, s6, s77
    s_add_u32 s7, s7, s77
    s_add_u32 s8, s8, s77
    s_add_u32 s9, s9, s77
    s_add_u32 s10, s10, s77
    s_mul_i32 s11, s93, 4096
    s_add_u32 s12, s11, 4096
    s_cmp_eq_u32 s12, 28672
    s_cselect_b32 s12, 0, s12
    s_add_u32 s13, s12, 4096
    s_cmp_eq_u32 s13, 28672
    s_cselect_b32 s13, 0, s13
    s_add_u32 s14, s13, 4096
    s_cmp_eq_u32 s14, 28672
    s_cselect_b32 s14, 0, s14
    s_add_u32 s15, s14, 4096
    s_cmp_eq_u32 s15, 28672
    s_cselect_b32 s15, 0, s15
    s_add_u32 s16, s15, 4096
    s_cmp_eq_u32 s16, 28672
    s_cselect_b32 s16, 0, s16
    s_add_u32 s17, s16, 4096
    s_cmp_eq_u32 s17, 28672
    s_cselect_b32 s17, 0, s17
    s_add_u32 s11, s11, s92
    s_add_u32 s12, s12, s92
    s_add_u32 s13, s13, s92
    s_add_u32 s14, s14, s92
    s_add_u32 s15, s15, s92
    s_add_u32 s16, s16, s92
    s_add_u32 s17, s17, s92
    s_mul_i32 s76, s67, 100352
    s_mov_b32 s84, -1
    s_mov_b32 s85, s93
    s_and_b32 s87, s67, 1
    s_mov_b32 s78, 4194304
    s_setprio 0
    s_add_u32 m0, s91, 0
    s_add_u32 s90, s76, 0
    buffer_load_dwordx4 v4, s[48:51], s90 offen lds
    s_add_u32 m0, s91, 1024
    s_add_u32 s90, s76, 7168
    buffer_load_dwordx4 v4, s[48:51], s90 offen lds
    s_add_u32 m0, s91, 2048
    s_add_u32 s90, s76, 14336
    buffer_load_dwordx4 v4, s[48:51], s90 offen lds
    s_add_u32 m0, s91, 3072
    s_add_u32 s90, s76, 21504
    buffer_load_dwordx4 v4, s[48:51], s90 offen lds
    s_add_u32 m0, s91, 4096
    s_add_u32 s90, s76, 28672
    buffer_load_dwordx4 v4, s[48:51], s90 offen lds
    s_add_u32 m0, s91, 5120
    s_add_u32 s90, s76, 35840
    buffer_load_dwordx4 v4, s[48:51], s90 offen lds
    s_add_u32 m0, s91, 6144
    s_add_u32 s90, s76, 43008
    buffer_load_dwordx4 v4, s[48:51], s90 offen lds
    s_add_u32 m0, s91, 7168
    s_add_u32 s90, s76, 50176
    buffer_load_dwordx4 v4, s[48:51], s90 offen lds
    s_add_u32 m0, s91, 8192
    s_add_u32 s90, s76, 50176
    buffer_load_dwordx4 v4, s[48:51], s90 offen lds
    s_add_u32 m0, s91, 9216
    s_add_u32 s90, s76, 57344
    buffer_load_dwordx4 v4, s[48:51], s90 offen lds
    s_add_u32 m0, s91, 10240
    s_add_u32 s90, s76, 64512
    buffer_load_dwordx4 v4, s[48:51], s90 offen lds
    s_add_u32 m0, s91, 11264
    s_add_u32 s90, s76, 71680
    buffer_load_dwordx4 v4, s[48:51], s90 offen lds
    s_add_u32 m0, s91, 12288
    s_add_u32 s90, s76, 78848
    buffer_load_dwordx4 v4, s[48:51], s90 offen lds
    s_add_u32 m0, s91, 13312
    s_add_u32 s90, s76, 86016
    buffer_load_dwordx4 v4, s[48:51], s90 offen lds
    s_add_u32 m0, s91, 14336
    s_add_u32 s90, s76, 93184
    buffer_load_dwordx4 v4, s[48:51], s90 offen lds
    s_add_u32 m0, s91, 15360
    s_add_u32 s90, s76, 100352
    buffer_load_dwordx4 v4, s[48:51], s90 offen lds
    s_waitcnt vmcnt(8)
    ds_read_b64_tr_b16 v[12:13], v2 offset:0
    ds_read_b64_tr_b16 v[14:15], v2 offset:1024
    ds_read_b64_tr_b16 v[16:17], v3 offset:0
    ds_read_b64_tr_b16 v[18:19], v3 offset:1024
    ds_read_b64_tr_b16 v[20:21], v2 offset:2048
    ds_read_b64_tr_b16 v[22:23], v2 offset:3072
    ds_read_b64_tr_b16 v[24:25], v3 offset:2048
    ds_read_b64_tr_b16 v[26:27], v3 offset:3072
    s_waitcnt lgkmcnt(0)
    ds_read_b64_tr_b16 v[32:33], v2 offset:3584
    ds_read_b64_tr_b16 v[34:35], v2 offset:4608
    ds_read_b64_tr_b16 v[36:37], v3 offset:3584
    ds_read_b64_tr_b16 v[38:39], v3 offset:4608
    ds_read_b64_tr_b16 v[40:41], v2 offset:5632
    ds_read_b64_tr_b16 v[42:43], v2 offset:6656
    ds_read_b64_tr_b16 v[44:45], v3 offset:5632
    ds_read_b64_tr_b16 v[46:47], v3 offset:6656
    s_waitcnt lgkmcnt(0)
    s_waitcnt vmcnt(0)
    ds_read_b64_tr_b16 v[48:49], v2 offset:8192
    ds_read_b64_tr_b16 v[50:51], v2 offset:9216
    ds_read_b64_tr_b16 v[52:53], v3 offset:8192
    ds_read_b64_tr_b16 v[54:55], v3 offset:9216
    ds_read_b64_tr_b16 v[216:217], v2 offset:10240
    ds_read_b64_tr_b16 v[218:219], v2 offset:11264
    ds_read_b64_tr_b16 v[220:221], v3 offset:10240
    ds_read_b64_tr_b16 v[222:223], v3 offset:11264
    s_waitcnt lgkmcnt(0)
    ds_read_b64_tr_b16 v[224:225], v2 offset:11776
    ds_read_b64_tr_b16 v[226:227], v2 offset:12800
    ds_read_b64_tr_b16 v[228:229], v3 offset:11776
    ds_read_b64_tr_b16 v[230:231], v3 offset:12800
    ds_read_b64_tr_b16 v[232:233], v2 offset:13824
    ds_read_b64_tr_b16 v[234:235], v2 offset:14848
    ds_read_b64_tr_b16 v[236:237], v3 offset:13824
    ds_read_b64_tr_b16 v[238:239], v3 offset:14848
    s_waitcnt lgkmcnt(0)
    s_add_u32 m0, s91, 0
    s_add_u32 s90, s4, 0
    buffer_load_dwordx4 v4, s[44:47], s90 offen lds
    s_add_u32 m0, s91, 1024
    s_add_u32 s90, s4, 7168
    buffer_load_dwordx4 v4, s[44:47], s90 offen lds
    s_add_u32 s74, s85, s87
    s_lshr_b32 s74, s74, 1
    s_lshl_b32 s74, 0x11, s74
    s_add_u32 s85, s85, 1
    s_cmp_eq_u32 s85, 7
    s_cselect_b32 s85, 0, s85
    s_and_b32 s75, s84, s74
    s_cbranch_scc0 L_ph0_ok
L_ph0:
    buffer_load_dword v6, v5, s[40:43], 0 offen sc1
    s_waitcnt vmcnt(0)
    s_setprio 1
    v_cmp_eq_u32 vcc, 0, v6
    s_setprio 0
    s_mov_b32 s84, vcc_lo
    s_and_b32 s75, s84, s74
    s_cbranch_scc0 L_ph0_ok
    s_sub_u32 s78, s78, 1
    s_cselect_b32 s78, 0, s78
    s_cbranch_scc1 L_ph0_ok
    s_sleep 4
    s_branch L_ph0
L_ph0_ok:
    s_add_u32 s90, s11, 0
    buffer_load_dwordx4 v[128:131], v29, s[40:43], s90 offen sc1
    s_add_u32 s90, s11, 114688
    buffer_load_dwordx4 v[132:135], v29, s[40:43], s90 offen sc1
    s_add_u32 m0, s91, 2048
    s_add_u32 s90, s4, 14336
    buffer_load_dwordx4 v4, s[44:47], s90 offen lds
    s_add_u32 m0, s91, 3072
    s_add_u32 s90, s4, 21504
    buffer_load_dwordx4 v4, s[44:47], s90 offen lds
    s_add_u32 s90, s11, 1024
    buffer_load_dwordx4 v[136:139], v29, s[40:43], s90 offen sc1
    s_add_u32 s90, s11, 115712
    buffer_load_dwordx4 v[140:143], v29, s[40:43], s90 offen sc1
    s_add_u32 m0, s91, 4096
    s_add_u32 s90, s4, 28672
    buffer_load_dwordx4 v4, s[44:47], s90 offen lds
    s_add_u32 m0, s91, 5120
    s_add_u32 s90, s4, 35840
    buffer_load_dwordx4 v4, s[44:47], s90 offen lds
    s_add_u32 s90, s11, 2048
    buffer_load_dwordx4 v[144:147], v29, s[40:43], s90 offen sc1
    s_add_u32 s90, s11, 116736
    buffer_load_dwordx4 v[148:151], v29, s[40:43], s90 offen sc1
    s_add_u32 m0, s91, 6144
    s_add_u32 s90, s4, 43008
    buffer_load_dwordx4 v4, s[44:47], s90 offen lds
    s_add_u32 m0, s91, 7168
    s_add_u32 s90, s4, 50176
    buffer_load_dwordx4 v4, s[44:47], s90 offen lds
    s_add_u32 s90, s11, 3072
    buffer_load_dwordx4 v[152:155], v29, s[40:43], s90 offen sc1
    s_add_u32 s90, s11, 117760
    buffer_load_dwordx4 v[156:159], v29, s[40:43], s90 offen sc1
    s_add_u32 m0, s91, 8192
    s_add_u32 s90, s5, 0
    buffer_load_dwordx4 v4, s[44:47], s90 offen lds
    s_add_u32 m0, s91, 9216
    s_add_u32 s90, s5, 7168
    buffer_load_dwordx4 v4, s[44:47], s90 offen lds
    s_add_u32 s74, s85, s87
    s_lshr_b32 s74, s74, 1
    s_lshl_b32 s74, 0x11, s74
    s_add_u32 s85, s85, 1
    s_cmp_eq_u32 s85, 7
    s_cselect_b32 s85, 0, s85
    s_and_b32 s75, s84, s74
    s_cbranch_scc0 L_ph1_ok
L_ph1:
    buffer_load_dword v6, v5, s[40:43], 0 offen sc1
    s_waitcnt vmcnt(0)
    s_setprio 1
    v_cmp_eq_u32 vcc, 0, v6
    s_setprio 0
    s_mov_b32 s84, vcc_lo
    s_and_b32 s75, s84, s74
    s_cbranch_scc0 L_ph1_ok
    s_sub_u32 s78, s78, 1
    s_cselect_b32 s78, 0, s78
    s_cbranch_scc1 L_ph1_ok
    s_sleep 4
    s_branch L_ph1
L_ph1_ok:
    s_add_u32 s90, s12, 0
    buffer_load_dwordx4 v[160:163], v29, s[40:43], s90 offen sc1
    s_add_u32 s90, s12, 114688
    buffer_load_dwordx4 v[164:167], v29, s[40:43], s90 offen sc1
    s_waitcnt vmcnt(14)
    ds_read_b64_tr_b16 v[240:241], v2 offset:0
    ds_read_b64_tr_b16 v[242:243], v2 offset:1024
    ds_read_b64_tr_b16 v[244:245], v3 offset:0
    ds_read_b64_tr_b16 v[246:247], v3 offset:1024
    ds_read_b64_tr_b16 v[248:249], v2 offset:2048
    ds_read_b64_tr_b16 v[250:251], v2 offset:3072
    ds_read_b64_tr_b16 v[252:253], v3 offset:2048
    ds_read_b64_tr_b16 v[254:255], v3 offset:3072
    s_mov_b32 s80, 15
    s_waitcnt lgkmcnt(6)
    v_mfma_f32_32x32x16_bf16 v[64:79], v[240:243], v[128:131], 0
    v_mfma_f32_32x32x16_bf16 v[80:95], v[240:243], v[132:135], 0
    s_waitcnt vmcnt(10)
    ds_read_b64_tr_b16 v[240:241], v2 offset:4096
    ds_read_b64_tr_b16 v[242:243], v2 offset:5120
    s_waitcnt lgkmcnt(6)
    v_mfma_f32_32x32x16_bf16 v[96:111], v[244:247], v[128:131], 0
    v_mfma_f32_32x32x16_bf16 v[112:127], v[244:247], v[132:135], 0
    ds_read_b64_tr_b16 v[244:245], v3 offset:4096
    ds_read_b64_tr_b16 v[246:247], v3 offset:5120
    s_add_u32 m0, s91, 10240
    s_add_u32 s90, s5, 14336
    buffer_load_dwordx4 v4, s[44:47], s90 offen lds
    s_add_u32 m0, s91, 11264
    s_add_u32 s90, s5, 21504
    buffer_load_dwordx4 v4, s[44:47], s90 offen lds
    s_add_u32 s90, s12, 1024
    buffer_load_dwordx4 v[168:171], v29, s[40:43], s90 offen sc1
    s_add_u32 s90, s12, 115712
    buffer_load_dwordx4 v[172:175], v29, s[40:43], s90 offen sc1
    s_waitcnt lgkmcnt(6)
    v_mfma_f32_32x32x16_bf16 v[64:79], v[248:251], v[136:139], v[64:79]
    v_mfma_f32_32x32x16_bf16 v[80:95], v[248:251], v[140:143], v[80:95]
    s_waitcnt vmcnt(10)
    ds_read_b64_tr_b16 v[248:249], v2 offset:6144
    ds_read_b64_tr_b16 v[250:251], v2 offset:7168
    s_waitcnt lgkmcnt(6)
    v_mfma_f32_32x32x16_bf16 v[96:111], v[252:255], v[136:139], v[96:111]
    v_mfma_f32_32x32x16_bf16 v[112:127], v[252:255], v[140:143], v[112:127]
    ds_read_b64_tr_b16 v[252:253], v3 offset:6144
    ds_read_b64_tr_b16 v[254:255], v3 offset:7168
    s_add_u32 m0, s91, 12288
    s_add_u32 s90, s5, 28672
    buffer_load_dwordx4 v4, s[44:47], s90 offen lds
    s_add_u32 m0, s91, 13312
    s_add_u32 s90, s5, 35840
    buffer_load_dwordx4 v4, s[44:47], s90 offen lds
    s_add_u32 s90, s12, 2048
    buffer_load_dwordx4 v[176:179], v29, s[40:43], s90 offen sc1
    s_add_u32 s90, s12, 116736
    buffer_load_dwordx4 v[180:183], v29, s[40:43], s90 offen sc1
    s_waitcnt lgkmcnt(6)
    v_mfma_f32_32x32x16_bf16 v[64:79], v[240:243], v[144:147], v[64:79]
    v_mfma_f32_32x32x16_bf16 v[80:95], v[240:243], v[148:151], v[80:95]
    s_waitcnt vmcnt(10)
    ds_read_b64_tr_b16 v[240:241], v2 offset:8192
    ds_read_b64_tr_b16 v[242:243], v2 offset:9216
    s_waitcnt lgkmcnt(6)
    v_mfma_f32_32x32x16_bf16 v[96:111], v[244:247], v[144:147], v[96:111]
    v_mfma_f32_32x32x16_bf16 v[112:127], v[244:247], v[148:151], v[112:127]
    ds_read_b64_tr_b16 v[244:245], v3 offset:8192
    ds_read_b64_tr_b16 v[246:247], v3 offset:9216
    s_add_u32 m0, s91, 14336
    s_add_u32 s90, s5, 43008
    buffer_load_dwordx4 v4, s[44:47], s90 offen lds
    s_add_u32 m0, s91, 15360
    s_add_u32 s90, s5, 50176
    buffer_load_dwordx4 v4, s[44:47], s90 offen lds
    s_add_u32 s90, s12, 3072
    buffer_load_dwordx4 v[184:187], v29, s[40:43], s90 offen sc1
    s_add_u32 s90, s12, 117760
    buffer_load_dwordx4 v[188:191], v29, s[40:43], s90 offen sc1
    s_waitcnt lgkmcnt(6)
    v_mfma_f32_32x32x16_bf16 v[64:79], v[248:251], v[152:155], v[64:79]
    v_mfma_f32_32x32x16_bf16 v[80:95], v[248:251], v[156:159], v[80:95]
    s_waitcnt vmcnt(10)
    ds_read_b64_tr_b16 v[248:249], v2 offset:10240
    ds_read_b64_tr_b16 v[250:251], v2 offset:11264
    s_waitcnt lgkmcnt(6)
    v_mfma_f32_32x32x16_bf16 v[96:111], v[252:255], v[152:155], v[96:111]
    v_mfma_f32_32x32x16_bf16 v[112:127], v[252:255], v[156:159], v[112:127]
    ds_read_b64_tr_b16 v[252:253], v3 offset:10240
    ds_read_b64_tr_b16 v[254:255], v3 offset:11264
    s_add_u32 m0, s91, 16384
    s_add_u32 s90, s6, 0
    buffer_load_dwordx4 v4, s[44:47], s90 offen lds
    s_add_u32 m0, s91, 17408
    s_add_u32 s90, s6, 7168
    buffer_load_dwordx4 v4, s[44:47], s90 offen lds
    s_add_u32 s74, s85, s87
    s_lshr_b32 s74, s74, 1
    s_lshl_b32 s74, 0x11, s74
    s_add_u32 s85, s85, 1
    s_cmp_eq_u32 s85, 7
    s_cselect_b32 s85, 0, s85
    s_and_b32 s75, s84, s74
    s_cbranch_scc0 L_ph2_ok
L_ph2:
    buffer_load_dword v6, v5, s[40:43], 0 offen sc1
    s_waitcnt vmcnt(0)
    s_setprio 1
    v_cmp_eq_u32 vcc, 0, v6
    s_setprio 0
    s_mov_b32 s84, vcc_lo
    s_and_b32 s75, s84, s74
    s_cbranch_scc0 L_ph2_ok
    s_sub_u32 s78, s78, 1
    s_cselect_b32 s78, 0, s78
    s_cbranch_scc1 L_ph2_ok
    s_sleep 4
    s_branch L_ph2
L_ph2_ok:
    s_add_u32 s90, s13, 0
    buffer_load_dwordx4 v[192:195], v29, s[40:43], s90 offen sc1
    s_add_u32 s90, s13, 114688
    buffer_load_dwordx4 v[196:199], v29, s[40:43], s90 offen sc1
    s_add_u32 m0, s91, 18432
    s_add_u32 s90, s6, 14336
    buffer_load_dwordx4 v4, s[44:47], s90 offen lds
    s_add_u32 m0, s91, 19456
    s_add_u32 s90, s6, 21504
    buffer_load_dwordx4 v4, s[44:47], s90 offen lds
    s_add_u32 s90, s13, 1024
    buffer_load_dwordx4 v[200:203], v29, s[40:43], s90 offen sc1
    s_add_u32 s90, s13, 115712
    buffer_load_dwordx4 v[204:207], v29, s[40:43], s90 offen sc1
    s_waitcnt lgkmcnt(6)
    v_mfma_f32_32x32x16_bf16 v[64:79], v[240:243], v[160:163], v[64:79]
    v_mfma_f32_32x32x16_bf16 v[80:95], v[240:243], v[164:167], v[80:95]
    s_waitcnt vmcnt(14)
    ds_read_b64_tr_b16 v[240:241], v2 offset:12288
    ds_read_b64_tr_b16 v[242:243], v2 offset:13312
    s_waitcnt lgkmcnt(6)
    v_mfma_f32_32x32x16_bf16 v[96:111], v[244:247], v[160:163], v[96:111]
    v_mfma_f32_32x32x16_bf16 v[112:127], v[244:247], v[164:167], v[112:127]
    ds_read_b64_tr_b16 v[244:245], v3 offset:12288
    ds_read_b64_tr_b16 v[246:247], v3 offset:13312
    s_add_u32 m0, s91, 20480
    s_add_u32 s90, s6, 28672
    buffer_load_dwordx4 v4, s[44:47], s90 offen lds
    s_add_u32 m0, s91, 21504
    s_add_u32 s90, s6, 35840
    buffer_load_dwordx4 v4, s[44:47], s90 offen lds
    s_add_u32 s90, s13, 2048
    buffer_load_dwordx4 v[208:211], v29, s[40:43], s90 offen sc1
    s_add_u32 s90, s13, 116736
    buffer_load_dwordx4 v[212:215], v29, s[40:43], s90 offen sc1
    s_add_u32 m0, s91, 22528
    s_add_u32 s90, s6, 43008
    buffer_load_dwordx4 v4, s[44:47], s90 offen lds
    s_add_u32 m0, s91, 23552
    s_add_u32 s90, s6, 50176
    buffer_load_dwordx4 v4, s[44:47], s90 offen lds
    s_add_u32 s90, s13, 3072
    buffer_load_dwordx4 v[128:131], v29, s[40:43], s90 offen sc1
    s_add_u32 s90, s13, 117760
    buffer_load_dwordx4 v[132:135], v29, s[40:43], s90 offen sc1
    s_waitcnt lgkmcnt(6)
    v_mfma_f32_32x32x16_bf16 v[64:79], v[248:251], v[168:171], v[64:79]
    v_mfma_f32_32x32x16_bf16 v[80:95], v[248:251], v[172:175], v[80:95]
    s_waitcnt vmcnt(18)
    ds_read_b64_tr_b16 v[248:249], v2 offset:14336
    ds_read_b64_tr_b16 v[250:251], v2 offset:15360
    s_waitcnt lgkmcnt(6)
    v_mfma_f32_32x32x16_bf16 v[96:111], v[252:255], v[168:171], v[96:111]
    v_mfma_f32_32x32x16_bf16 v[112:127], v[252:255], v[172:175], v[112:127]
    ds_read_b64_tr_b16 v[252:253], v3 offset:14336
    ds_read_b64_tr_b16 v[254:255], v3 offset:15360
    s_add_u32 m0, s91, 0
    s_add_u32 s90, s7, 0
    buffer_load_dwordx4 v4, s[44:47], s90 offen lds
    s_add_u32 m0, s91, 1024
    s_add_u32 s90, s7, 7168
    buffer_load_dwordx4 v4, s[44:47], s90 offen lds
    s_add_u32 s74, s85, s87
    s_lshr_b32 s74, s74, 1
    s_lshl_b32 s74, 0x11, s74
    s_add_u32 s85, s85, 1
    s_cmp_eq_u32 s85, 7
    s_cselect_b32 s85, 0, s85
    s_and_b32 s75, s84, s74
    s_cbranch_scc0 L_ph3_ok
L_ph3:
    buffer_load_dword v6, v5, s[40:43], 0 offen sc1
    s_waitcnt vmcnt(0)
    s_setprio 1
    v_cmp_eq_u32 vcc, 0, v6
    s_setprio 0
    s_mov_b32 s84, vcc_lo
    s_and_b32 s75, s84, s74
    s_cbranch_scc0 L_ph3_ok
    s_sub_u32 s78, s78, 1
    s_cselect_b32 s78, 0, s78
    s_cbranch_scc1 L_ph3_ok
    s_sleep 4
    s_branch L_ph3
L_ph3_ok:
    s_add_u32 s90, s14, 0
    buffer_load_dwordx4 v[136:139], v29, s[40:43], s90 offen sc1
    s_add_u32 s90, s14, 114688
    buffer_load_dwordx4 v[140:143], v29, s[40:43], s90 offen sc1
    s_waitcnt vmcnt(20)
    s_add_u32 m0, s91, 2048
    s_add_u32 s90, s7, 14336
    buffer_load_dwordx4 v4, s[44:47], s90 offen lds
    s_add_u32 m0, s91, 3072
    s_add_u32 s90, s7, 21504
    buffer_load_dwordx4 v4, s[44:47], s90 offen lds
    s_add_u32 s90, s14, 1024
    buffer_load_dwordx4 v[144:147], v29, s[40:43], s90 offen sc1
    s_add_u32 s90, s14, 115712
    buffer_load_dwordx4 v[148:151], v29, s[40:43], s90 offen sc1
    s_waitcnt lgkmcnt(6)
    v_mfma_f32_32x32x16_bf16 v[64:79], v[240:243], v[176:179], v[64:79]
    v_mfma_f32_32x32x16_bf16 v[80:95], v[240:243], v[180:183], v[80:95]
    s_waitcnt vmcnt(22)
    ds_read_b64_tr_b16 v[240:241], v2 offset:16384
    ds_read_b64_tr_b16 v[242:243], v2 offset:17408
    s_waitcnt lgkmcnt(6)
    v_mfma_f32_32x32x16_bf16 v[96:111], v[244:247], v[176:179], v[96:111]
    v_mfma_f32_32x32x16_bf16 v[112:127], v[244:247], v[180:183], v[112:127]
    ds_read_b64_tr_b16 v[244:245], v3 offset:16384
    ds_read_b64_tr_b16 v[246:247], v3 offset:17408
    s_waitcnt vmcnt(20)
    s_add_u32 m0, s91, 4096
    s_add_u32 s90, s7, 28672
    buffer_load_dwordx4 v4, s[44:47], s90 offen lds
    s_add_u32 m0, s91, 5120
    s_add_u32 s90, s7, 35840
    buffer_load_dwordx4 v4, s[44:47], s90 offen lds
    s_add_u32 s90, s14, 2048
    buffer_load_dwordx4 v[152:155], v29, s[40:43], s90 offen sc1
    s_add_u32 s90, s14, 116736
    buffer_load_dwordx4 v[156:159], v29, s[40:43], s90 offen sc1
    s_waitcnt vmcnt(20)
    s_add_u32 m0, s91, 6144
    s_add_u32 s90, s7, 43008
    buffer_load_dwordx4 v4, s[44:47], s90 offen lds
    s_add_u32 m0, s91, 7168
    s_add_u32 s90, s7, 50176
    buffer_load_dwordx4 v4, s[44:47], s90 offen lds
    s_add_u32 s90, s14, 3072
    buffer_load_dwordx4 v[160:163], v29, s[40:43], s90 offen sc1
    s_add_u32 s90, s14, 117760
    buffer_load_dwordx4 v[164:167], v29, s[40:43], s90 offen sc1
    s_waitcnt lgkmcnt(6)
    v_mfma_f32_32x32x16_bf16 v[64:79], v[248:251], v[184:187], v[64:79]
    v_mfma_f32_32x32x16_bf16 v[80:95], v[248:251], v[188:191], v[80:95]
    ds_read_b64_tr_b16 v[248:249], v2 offset:18432
    ds_read_b64_tr_b16 v[250:251], v2 offset:19456
    s_waitcnt lgkmcnt(6)
    v_mfma_f32_32x32x16_bf16 v[96:111], v[252:255], v[184:187], v[96:111]
    v_mfma_f32_32x32x16_bf16 v[112:127], v[252:255], v[188:191], v[112:127]
    ds_read_b64_tr_b16 v[252:253], v3 offset:18432
    ds_read_b64_tr_b16 v[254:255], v3 offset:19456
    s_waitcnt vmcnt(20)
    s_add_u32 m0, s91, 8192
    s_add_u32 s90, s8, 0
    buffer_load_dwordx4 v4, s[44:47], s90 offen lds
    s_add_u32 m0, s91, 9216
    s_add_u32 s90, s8, 7168
    buffer_load_dwordx4 v4, s[44:47], s90 offen lds
    s_add_u32 s74, s85, s87
    s_lshr_b32 s74, s74, 1
    s_lshl_b32 s74, 0x11, s74
    s_add_u32 s85, s85, 1
    s_cmp_eq_u32 s85, 7
    s_cselect_b32 s85, 0, s85
    s_and_b32 s75, s84, s74
    s_cbranch_scc0 L_ph4_ok
L_ph4:
    buffer_load_dword v6, v5, s[40:43], 0 offen sc1
    s_waitcnt vmcnt(0)
    s_setprio 1
    v_cmp_eq_u32 vcc, 0, v6
    s_setprio 0
    s_mov_b32 s84, vcc_lo
    s_and_b32 s75, s84, s74
    s_cbranch_scc0 L_ph4_ok
    s_sub_u32 s78, s78, 1
    s_cselect_b32 s78, 0, s78
    s_cbranch_scc1 L_ph4_ok
    s_sleep 4
    s_branch L_ph4
L_ph4_ok:
    s_add_u32 s90, s15, 0
    buffer_load_dwordx4 v[168:171], v29, s[40:43], s90 offen sc1
    s_add_u32 s90, s15, 114688
    buffer_load_dwordx4 v[172:175], v29, s[40:43], s90 offen sc1
    s_waitcnt vmcnt(20)
    s_add_u32 m0, s91, 10240
    s_add_u32 s90, s8, 14336
    buffer_load_dwordx4 v4, s[44:47], s90 offen lds
    s_add_u32 m0, s91, 11264
    s_add_u32 s90, s8, 21504
    buffer_load_dwordx4 v4, s[44:47], s90 offen lds
    s_add_u32 s90, s15, 1024
    buffer_load_dwordx4 v[176:179], v29, s[40:43], s90 offen sc1
    s_add_u32 s90, s15, 115712
    buffer_load_dwordx4 v[180:183], v29, s[40:43], s90 offen sc1
    buffer_load_dword v11, v28, s[40:43], 0 offen sc1
    s_waitcnt lgkmcnt(6)
    v_mfma_f32_32x32x16_bf16 v[64:79], v[240:243], v[192:195], v[64:79]
    v_mfma_f32_32x32x16_bf16 v[80:95], v[240:243], v[196:199], v[80:95]
    ds_read_b64_tr_b16 v[240:241], v2 offset:20480
    ds_read_b64_tr_b16 v[242:243], v2 offset:21504
    s_waitcnt lgkmcnt(6)
    v_mfma_f32_32x32x16_bf16 v[96:111], v[244:247], v[192:195], v[96:111]
    v_mfma_f32_32x32x16_bf16 v[112:127], v[244:247], v[196:199], v[112:127]
    ds_read_b64_tr_b16 v[244:245], v3 offset:20480
    ds_read_b64_tr_b16 v[246:247], v3 offset:21504
    s_waitcnt vmcnt(20)
    s_add_u32 m0, s91, 12288
    s_add_u32 s90, s8, 28672
    buffer_load_dwordx4 v4, s[44:47], s90 offen lds
    s_add_u32 m0, s91, 13312
    s_add_u32 s90, s8, 35840
    buffer_load_dwordx4 v4, s[44:47], s90 offen lds
    s_add_u32 s90, s15, 2048
    buffer_load_dwordx4 v[184:187], v29, s[40:43], s90 offen sc1
    s_add_u32 s90, s15, 116736
    buffer_load_dwordx4 v[188:191], v29, s[40:43], s90 offen sc1
    s_waitcnt vmcnt(20)
    s_add_u32 m0, s91, 14336
    s_add_u32 s90, s8, 43008
    buffer_load_dwordx4 v4, s[44:47], s90 offen lds
    s_add_u32 m0, s91, 15360
    s_add_u32 s90, s8, 50176
    buffer_load_dwordx4 v4, s[44:47], s90 offen lds
    s_add_u32 s90, s15, 3072
    buffer_load_dwordx4 v[192:195], v29, s[40:43], s90 offen sc1
    s_add_u32 s90, s15, 117760
    buffer_load_dwordx4 v[196:199], v29, s[40:43], s90 offen sc1
    s_waitcnt lgkmcnt(6)
    v_mfma_f32_32x32x16_bf16 v[64:79], v[248:251], v[200:203], v[64:79]
    v_mfma_f32_32x32x16_bf16 v[80:95], v[248:251], v[204:207], v[80:95]
    ds_read_b64_tr_b16 v[248:249], v2 offset:22528
    ds_read_b64_tr_b16 v[250:251], v2 offset:23552
    s_waitcnt lgkmcnt(6)
    v_mfma_f32_32x32x16_bf16 v[96:111], v[252:255], v[200:203], v[96:111]
    v_mfma_f32_32x32x16_bf16 v[112:127], v[252:255], v[204:207], v[112:127]
    ds_read_b64_tr_b16 v[252:253], v3 offset:22528
    ds_read_b64_tr_b16 v[254:255], v3 offset:23552
    s_waitcnt vmcnt(20)
    s_add_u32 m0, s91, 16384
    s_add_u32 s90, s9, 0
    buffer_load_dwordx4 v4, s[44:47], s90 offen lds
    s_add_u32 m0, s91, 17408
    s_add_u32 s90, s9, 7168
    buffer_load_dwordx4 v4, s[44:47], s90 offen lds
    s_add_u32 s74, s85, s87
    s_lshr_b32 s74, s74, 1
    s_lshl_b32 s74, 0x11, s74
    s_add_u32 s85, s85, 1
    s_cmp_eq_u32 s85, 7
    s_cselect_b32 s85, 0, s85
    s_and_b32 s75, s84, s74
    s_cbranch_scc0 L_ph5_ok
L_ph5:
    buffer_load_dword v6, v5, s[40:43], 0 offen sc1
    s_waitcnt vmcnt(0)
    s_setprio 1
    v_cmp_eq_u32 vcc, 0, v6
    s_setprio 0
    s_mov_b32 s84, vcc_lo
    s_and_b32 s75, s84, s74
    s_cbranch_scc0 L_ph5_ok
    s_sub_u32 s78, s78, 1
    s_cselect_b32 s78, 0, s78
    s_cbranch_scc1 L_ph5_ok
    s_sleep 4
    s_branch L_ph5
L_ph5_ok:
    s_add_u32 s90, s16, 0
    buffer_load_dwordx4 v[200:203], v29, s[40:43], s90 offen sc1
    s_add_u32 s90, s16, 114688
    buffer_load_dwordx4 v[204:207], v29, s[40:43], s90 offen sc1
    s_waitcnt vmcnt(12)
    s_setprio 1
    v_cmp_eq_u32 vcc, 0, v11
    s_setprio 0
    s_bitcmp1_b32 s67, 0
    s_cselect_b32 s75, 7, 15
    s_and_b32 s74, vcc_lo, s75
    s_cbranch_scc1 L_pm_slow
L_pm_back:
    s_waitcnt lgkmcnt(6)
    v_mfma_f32_32x32x16_bf16 v[64:79], v[240:243], v[208:211], v[64:79]
    v_mfma_f32_32x32x16_bf16 v[80:95], v[240:243], v[212:215], v[80:95]
    ds_read_b64_tr_b16 v[240:241], v2 offset:0
    ds_read_b64_tr_b16 v[242:243], v2 offset:1024
    s_waitcnt lgkmcnt(6)
    v_mfma_f32_32x32x16_bf16 v[96:111], v[244:247], v[208:211], v[96:111]
    v_mfma_f32_32x32x16_bf16 v[112:127], v[244:247], v[212:215], v[112:127]
    ds_read_b64_tr_b16 v[244:245], v3 offset:0
    ds_read_b64_tr_b16 v[246:247], v3 offset:1024
    s_add_u32 m0, s91, 18432
    s_add_u32 s90, s9, 14336
    buffer_load_dwordx4 v4, s[44:47], s90 offen lds
    s_add_u32 m0, s91, 19456
    s_add_u32 s90, s9, 21504
    buffer_load_dwordx4 v4, s[44:47], s90 offen lds
    s_add_u32 s90, s16, 1024
    buffer_load_dwordx4 v[208:211], v29, s[40:43], s90 offen sc1
    s_add_u32 s90, s16, 115712
    buffer_load_dwordx4 v[212:215], v29, s[40:43], s90 offen sc1
    s_waitcnt lgkmcnt(6)
    v_mfma_f32_32x32x16_bf16 v[64:79], v[248:251], v[128:131], v[64:79]
    v_mfma_f32_32x32x16_bf16 v[80:95], v[248:251], v[132:135], v[80:95]
    ds_read_b64_tr_b16 v[248:249], v2 offset:2048
    ds_read_b64_tr_b16 v[250:251], v2 offset:3072
    s_waitcnt lgkmcnt(6)
    v_mfma_f32_32x32x16_bf16 v[96:111], v[252:255], v[128:131], v[96:111]
    v_mfma_f32_32x32x16_bf16 v[112:127], v[252:255], v[132:135], v[112:127]
    ds_read_b64_tr_b16 v[252:253], v3 offset:2048
    ds_read_b64_tr_b16 v[254:255], v3 offset:3072
    s_add_u32 m0, s91, 20480
    s_add_u32 s90, s9, 28672
    buffer_load_dwordx4 v4, s[44:47], s90 offen lds
    s_add_u32 m0, s91, 21504
    s_add_u32 s90, s9, 35840
    buffer_load_dwordx4 v4, s[44:47], s90 offen lds
    s_add_u32 s90, s16, 2048
    buffer_load_dwordx4 v[128:131], v29, s[40:43], s90 offen sc1
    s_add_u32 s90, s16, 116736
    buffer_load_dwordx4 v[132:135], v29, s[40:43], s90 offen sc1
    s_waitcnt lgkmcnt(6)
    v_mfma_f32_32x32x16_bf16 v[64:79], v[240:243], v[136:139], v[64:79]
    v_mfma_f32_32x32x16_bf16 v[80:95], v[240:243], v[140:143], v[80:95]
    ds_read_b64_tr_b16 v[240:241], v2 offset:4096
    ds_read_b64_tr_b16 v[242:243], v2 offset:5120
    s_waitcnt lgkmcnt(6)
    v_mfma_f32_32x32x16_bf16 v[96:111], v[244:247], v[136:139], v[96:111]
    v_mfma_f32_32x32x16_bf16 v[112:127], v[244:247], v[140:143], v[112:127]
    ds_read_b64_tr_b16 v[244:245], v3 offset:4096
    ds_read_b64_tr_b16 v[246:247], v3 offset:5120
    s_add_u32 m0, s91, 22528
    s_add_u32 s90, s9, 43008
    buffer_load_dwordx4 v4, s[44:47], s90 offen lds
    s_add_u32 m0, s91, 23552
    s_add_u32 s90, s9, 50176
    buffer_load_dwordx4 v4, s[44:47], s90 offen lds
    s_add_u32 s90, s16, 3072
    buffer_load_dwordx4 v[136:139], v29, s[40:43], s90 offen sc1
    s_add_u32 s90, s16, 117760
    buffer_load_dwordx4 v[140:143], v29, s[40:43], s90 offen sc1
    s_waitcnt lgkmcnt(6)
    v_mfma_f32_32x32x16_bf16 v[64:79], v[248:251], v[144:147], v[64:79]
    v_mfma_f32_32x32x16_bf16 v[80:95], v[248:251], v[148:151], v[80:95]
    ds_read_b64_tr_b16 v[248:249], v2 offset:6144
    ds_read_b64_tr_b16 v[250:251], v2 offset:7168
    s_waitcnt lgkmcnt(6)
    v_mfma_f32_32x32x16_bf16 v[96:111], v[252:255], v[144:147], v[96:111]
    v_mfma_f32_32x32x16_bf16 v[112:127], v[252:255], v[148:151], v[112:127]
    ds_read_b64_tr_b16 v[252:253], v3 offset:6144
    ds_read_b64_tr_b16 v[254:255], v3 offset:7168
    s_waitcnt vmcnt(20)
    s_add_u32 m0, s91, 0
    s_add_u32 s90, s10, 0
    buffer_load_dwordx4 v4, s[44:47], s90 offen lds
    s_add_u32 m0, s91, 1024
    s_add_u32 s90, s10, 7168
    buffer_load_dwordx4 v4, s[44:47], s90 offen lds
    s_add_u32 s74, s85, s87
    s_lshr_b32 s74, s74, 1
    s_lshl_b32 s74, 0x11, s74
    s_add_u32 s85, s85, 1
    s_cmp_eq_u32 s85, 7
    s_cselect_b32 s85, 0, s85
    s_and_b32 s75, s84, s74
    s_cbranch_scc0 L_ph6_ok
L_ph6:
    buffer_load_dword v6, v5, s[40:43], 0 offen sc1
    s_waitcnt vmcnt(0)
    s_setprio 1
    v_cmp_eq_u32 vcc, 0, v6
    s_setprio 0
    s_mov_b32 s84, vcc_lo
    s_and_b32 s75, s84, s74
    s_cbranch_scc0 L_ph6_ok
    s_sub_u32 s78, s78, 1
    s_cselect_b32 s78, 0, s78
    s_cbranch_scc1 L_ph6_ok
    s_sleep 4
    s_branch L_ph6
L_ph6_ok:
    s_add_u32 s90, s17, 0
    buffer_load_dwordx4 v[144:147], v29, s[40:43], s90 offen sc1
    s_add_u32 s90, s17, 114688
    buffer_load_dwordx4 v[148:151], v29, s[40:43], s90 offen sc1
    s_waitcnt lgkmcnt(6)
    v_mfma_f32_32x32x16_bf16 v[64:79], v[240:243], v[152:155], v[64:79]
    v_mfma_f32_32x32x16_bf16 v[80:95], v[240:243], v[156:159], v[80:95]
    ds_read_b64_tr_b16 v[240:241], v2 offset:8192
    ds_read_b64_tr_b16 v[242:243], v2 offset:9216
    s_waitcnt lgkmcnt(6)
    v_mfma_f32_32x32x16_bf16 v[96:111], v[244:247], v[152:155], v[96:111]
    v_mfma_f32_32x32x16_bf16 v[112:127], v[244:247], v[156:159], v[112:127]
    ds_read_b64_tr_b16 v[244:245], v3 offset:8192
    ds_read_b64_tr_b16 v[246:247], v3 offset:9216
    s_waitcnt vmcnt(20)
    s_add_u32 m0, s91, 2048
    s_add_u32 s90, s10, 14336
    buffer_load_dwordx4 v4, s[44:47], s90 offen lds
    s_add_u32 m0, s91, 3072
    s_add_u32 s90, s10, 21504
    buffer_load_dwordx4 v4, s[44:47], s90 offen lds
    s_add_u32 s90, s17, 1024
    buffer_load_dwordx4 v[152:155], v29, s[40:43], s90 offen sc1
    s_add_u32 s90, s17, 115712
    buffer_load_dwordx4 v[156:159], v29, s[40:43], s90 offen sc1
    s_setprio 1
    v_and_b32 v8, 31, v1
    v_lshrrev_b32 v9, 5, v1
    v_mul_u32_u24 v8, 144, v8
    v_lshl_add_u32 v8, v9, 3, v8
    v_add_u32 v8, s91, v8
    v_add_u32 v9, 4608, v8
    v_mov_b32 v10, 58368
    v_lshrrev_b32 v57, 3, v1
    v_and_b32 v58, 7, v1
    v_mul_u32_u24 v56, 896, v57
    v_lshl_add_u32 v56, v58, 4, v56
    s_lshl_b32 s74, s68, 7
    s_lshl_b32 s75, s81, 6
    s_add_u32 s74, s74, s75
    s_lshl_b32 s75, s66, 3
    s_add_u32 s74, s74, s75
    s_mul_i32 s74, s74, 896
    s_lshl_b32 s76, s82, 7
    s_add_u32 s74, s74, s76
    v_add_u32 v56, s74, v56
    buffer_load_dwordx4 v[60:63], v56, s[28:31], 0 offen
    v_add_u32 v57, s75, v57
    v_mul_u32_u24 v57, 144, v57
    v_lshl_add_u32 v57, v58, 4, v57
    v_add_u32 v57, 65536, v57
    v_add_u32 v58, 49152, v57
    s_setprio 0
    s_mov_b32 s78, 8388608
    ds_read_b32 v11, v10
L_g4:
    s_waitcnt lgkmcnt(0)
    s_setprio 1
    v_readfirstlane_b32 s74, v11
    s_setprio 0
    s_cmp_ge_u32 s74, 4
    s_cbranch_scc1 L_g4_ok
    s_sub_u32 s78, s78, 1
    s_cbranch_scc1 L_g4_ok
    s_sleep 2
    ds_read_b32 v11, v10
    s_branch L_g4
L_g4_ok:
    v_mfma_f32_32x32x16_bf16 v[64:79], v[248:251], v[160:163], v[64:79]
    v_mfma_f32_32x32x16_bf16 v[80:95], v[248:251], v[164:167], v[80:95]
    ds_read_b64_tr_b16 v[248:249], v2 offset:10240
    ds_read_b64_tr_b16 v[250:251], v2 offset:11264
    v_mfma_f32_32x32x16_bf16 v[96:111], v[252:255], v[160:163], v[96:111]
    v_mfma_f32_32x32x16_bf16 v[112:127], v[252:255], v[164:167], v[112:127]
    ds_read_b64_tr_b16 v[252:253], v3 offset:10240
    ds_read_b64_tr_b16 v[254:255], v3 offset:11264
    s_add_u32 m0, s91, 4096
    s_add_u32 s90, s10, 28672
    buffer_load_dwordx4 v4, s[44:47], s90 offen lds
    s_add_u32 m0, s91, 5120
    s_add_u32 s90, s10, 35840
    buffer_load_dwordx4 v4, s[44:47], s90 offen lds
    s_add_u32 s90, s17, 2048
    buffer_load_dwordx4 v[160:163], v29, s[40:43], s90 offen sc1
    s_add_u32 s90, s17, 116736
    buffer_load_dwordx4 v[164:167], v29, s[40:43], s90 offen sc1
    v_mfma_f32_32x32x16_bf16 v[64:79], v[240:243], v[168:171], v[64:79]
    v_mfma_f32_32x32x16_bf16 v[80:95], v[240:243], v[172:175], v[80:95]
    ds_read_b64_tr_b16 v[240:241], v2 offset:12288
    ds_read_b64_tr_b16 v[242:243], v2 offset:13312
    v_mfma_f32_32x32x16_bf16 v[96:111], v[244:247], v[168:171], v[96:111]
    v_mfma_f32_32x32x16_bf16 v[112:127], v[244:247], v[172:175], v[112:127]
    ds_read_b64_tr_b16 v[244:245], v3 offset:12288
    ds_read_b64_tr_b16 v[246:247], v3 offset:13312
    s_add_u32 m0, s91, 6144
    s_add_u32 s90, s10, 43008
    buffer_load_dwordx4 v4, s[44:47], s90 offen lds
    s_add_u32 m0, s91, 7168
    s_add_u32 s90, s10, 50176
    buffer_load_dwordx4 v4, s[44:47], s90 offen lds
    s_add_u32 s90, s17, 3072
    buffer_load_dwordx4 v[168:171], v29, s[40:43], s90 offen sc1
    s_add_u32 s90, s17, 117760
    buffer_load_dwordx4 v[172:175], v29, s[40:43], s90 offen sc1
    s_waitcnt lgkmcnt(6)
    v_mfma_f32_32x32x16_bf16 v[64:79], v[248:251], v[176:179], v[64:79]
    v_mfma_f32_32x32x16_bf16 v[80:95], v[248:251], v[180:183], v[80:95]
    ds_read_b64_tr_b16 v[248:249], v2 offset:14336
    ds_read_b64_tr_b16 v[250:251], v2 offset:15360
    s_waitcnt lgkmcnt(6)
    v_mfma_f32_32x32x16_bf16 v[96:111], v[252:255], v[176:179], v[96:111]
    v_mfma_f32_32x32x16_bf16 v[112:127], v[252:255], v[180:183], v[112:127]
    ds_read_b64_tr_b16 v[252:253], v3 offset:14336
    ds_read_b64_tr_b16 v[254:255], v3 offset:15360
    s_waitcnt lgkmcnt(6)
    v_mfma_f32_32x32x16_bf16 v[64:79], v[240:243], v[184:187], v[64:79]
    v_mfma_f32_32x32x16_bf16 v[80:95], v[240:243], v[188:191], v[80:95]
    s_waitcnt vmcnt(31)
    ds_read_b64_tr_b16 v[240:241], v2 offset:16384
    ds_read_b64_tr_b16 v[242:243], v2 offset:17408
    s_waitcnt lgkmcnt(6)
    v_mfma_f32_32x32x16_bf16 v[96:111], v[244:247], v[184:187], v[96:111]
    v_mfma_f32_32x32x16_bf16 v[112:127], v[244:247], v[188:191], v[112:127]
    ds_read_b64_tr_b16 v[244:245], v3 offset:16384
    ds_read_b64_tr_b16 v[246:247], v3 offset:17408
    s_waitcnt lgkmcnt(6)
    v_mfma_f32_32x32x16_bf16 v[64:79], v[248:251], v[192:195], v[64:79]
    v_mfma_f32_32x32x16_bf16 v[80:95], v[248:251], v[196:199], v[80:95]
    s_waitcnt vmcnt(27)
    ds_read_b64_tr_b16 v[248:249], v2 offset:18432
    ds_read_b64_tr_b16 v[250:251], v2 offset:19456
    s_waitcnt lgkmcnt(6)
    v_mfma_f32_32x32x16_bf16 v[96:111], v[252:255], v[192:195], v[96:111]
    v_mfma_f32_32x32x16_bf16 v[112:127], v[252:255], v[196:199], v[112:127]
    ds_read_b64_tr_b16 v[252:253], v3 offset:18432
    ds_read_b64_tr_b16 v[254:255], v3 offset:19456
    s_waitcnt lgkmcnt(6)
    v_mfma_f32_32x32x16_bf16 v[64:79], v[240:243], v[200:203], v[64:79]
    v_mfma_f32_32x32x16_bf16 v[80:95], v[240:243], v[204:207], v[80:95]
    s_waitcnt vmcnt(23)
    ds_read_b64_tr_b16 v[240:241], v2 offset:20480
    ds_read_b64_tr_b16 v[242:243], v2 offset:21504
    s_waitcnt lgkmcnt(6)
    v_mfma_f32_32x32x16_bf16 v[96:111], v[244:247], v[200:203], v[96:111]
    v_mfma_f32_32x32x16_bf16 v[112:127], v[244:247], v[204:207], v[112:127]
    ds_read_b64_tr_b16 v[244:245], v3 offset:20480
    ds_read_b64_tr_b16 v[246:247], v3 offset:21504
    s_waitcnt lgkmcnt(6)
    v_mfma_f32_32x32x16_bf16 v[64:79], v[248:251], v[208:211], v[64:79]
    v_mfma_f32_32x32x16_bf16 v[80:95], v[248:251], v[212:215], v[80:95]
    s_waitcnt vmcnt(19)
    ds_read_b64_tr_b16 v[248:249], v2 offset:22528
    ds_read_b64_tr_b16 v[250:251], v2 offset:23552
    s_waitcnt lgkmcnt(6)
    v_mfma_f32_32x32x16_bf16 v[96:111], v[252:255], v[208:211], v[96:111]
    v_mfma_f32_32x32x16_bf16 v[112:127], v[252:255], v[212:215], v[112:127]
    ds_read_b64_tr_b16 v[252:253], v3 offset:22528
    ds_read_b64_tr_b16 v[254:255], v3 offset:23552
    s_waitcnt lgkmcnt(6)
    v_mfma_f32_32x32x16_bf16 v[64:79], v[240:243], v[128:131], v[64:79]
    v_mfma_f32_32x32x16_bf16 v[80:95], v[240:243], v[132:135], v[80:95]
    s_waitcnt vmcnt(15)
    ds_read_b64_tr_b16 v[240:241], v2 offset:0
    ds_read_b64_tr_b16 v[242:243], v2 offset:1024
    s_waitcnt lgkmcnt(6)
    v_mfma_f32_32x32x16_bf16 v[96:111], v[244:247], v[128:131], v[96:111]
    v_mfma_f32_32x32x16_bf16 v[112:127], v[244:247], v[132:135], v[112:127]
    ds_read_b64_tr_b16 v[244:245], v3 offset:0
    ds_read_b64_tr_b16 v[246:247], v3 offset:1024
    s_waitcnt lgkmcnt(6)
    v_mfma_f32_32x32x16_bf16 v[64:79], v[248:251], v[136:139], v[64:79]
    v_mfma_f32_32x32x16_bf16 v[80:95], v[248:251], v[140:143], v[80:95]
    s_waitcnt vmcnt(11)
    ds_read_b64_tr_b16 v[248:249], v2 offset:2048
    ds_read_b64_tr_b16 v[250:251], v2 offset:3072
    s_waitcnt lgkmcnt(6)
    v_mfma_f32_32x32x16_bf16 v[96:111], v[252:255], v[136:139], v[96:111]
    v_mfma_f32_32x32x16_bf16 v[112:127], v[252:255], v[140:143], v[112:127]
    ds_read_b64_tr_b16 v[252:253], v3 offset:2048
    ds_read_b64_tr_b16 v[254:255], v3 offset:3072
    s_waitcnt lgkmcnt(6)
    v_mfma_f32_32x32x16_bf16 v[64:79], v[240:243], v[144:147], v[64:79]
    v_mfma_f32_32x32x16_bf16 v[80:95], v[240:243], v[148:151], v[80:95]
    s_waitcnt vmcnt(6)
    ds_read_b64_tr_b16 v[240:241], v2 offset:4096
    ds_read_b64_tr_b16 v[242:243], v2 offset:5120
    s_waitcnt lgkmcnt(6)
    v_mfma_f32_32x32x16_bf16 v[96:111], v[244:247], v[144:147], v[96:111]
    v_mfma_f32_32x32x16_bf16 v[112:127], v[244:247], v[148:151], v[112:127]
    ds_read_b64_tr_b16 v[244:245], v3 offset:4096
    ds_read_b64_tr_b16 v[246:247], v3 offset:5120
    s_waitcnt lgkmcnt(6)
    v_mfma_f32_32x32x16_bf16 v[64:79], v[248:251], v[152:155], v[64:79]
    v_mfma_f32_32x32x16_bf16 v[80:95], v[248:251], v[156:159], v[80:95]
    s_waitcnt vmcnt(2)
    ds_read_b64_tr_b16 v[248:249], v2 offset:6144
    ds_read_b64_tr_b16 v[250:251], v2 offset:7168
    s_waitcnt lgkmcnt(6)
    v_mfma_f32_32x32x16_bf16 v[96:111], v[252:255], v[152:155], v[96:111]
    v_mfma_f32_32x32x16_bf16 v[112:127], v[252:255], v[156:159], v[112:127]
    ds_read_b64_tr_b16 v[252:253], v3 offset:6144
    ds_read_b64_tr_b16 v[254:255], v3 offset:7168
    s_waitcnt lgkmcnt(6)
    v_mfma_f32_32x32x16_bf16 v[64:79], v[240:243], v[160:163], v[64:79]
    v_mfma_f32_32x32x16_bf16 v[80:95], v[240:243], v[164:167], v[80:95]
    s_waitcnt lgkmcnt(4)
    v_mfma_f32_32x32x16_bf16 v[96:111], v[244:247], v[160:163], v[96:111]
    v_mfma_f32_32x32x16_bf16 v[112:127], v[244:247], v[164:167], v[112:127]
    s_waitcnt vmcnt(0)
    s_waitcnt lgkmcnt(2)
    v_mfma_f32_32x32x16_bf16 v[64:79], v[248:251], v[168:171], v[64:79]
    v_mfma_f32_32x32x16_bf16 v[80:95], v[248:251], v[172:175], v[80:95]
    s_waitcnt lgkmcnt(0)
    v_mfma_f32_32x32x16_bf16 v[96:111], v[252:255], v[168:171], v[96:111]
    v_mfma_f32_32x32x16_bf16 v[112:127], v[252:255], v[172:175], v[112:127]
    s_add_u32 s90, s79, 0
    buffer_load_dwordx4 v[176:179], v29, s[40:43], s90 offen sc1
    s_add_u32 s90, s79, 32768
    buffer_load_dwordx4 v[180:183], v29, s[40:43], s90 offen sc1
    s_add_u32 s90, s79, 1024
    buffer_load_dwordx4 v[184:187], v29, s[40:43], s90 offen sc1
    s_add_u32 s90, s79, 33792
    buffer_load_dwordx4 v[188:191], v29, s[40:43], s90 offen sc1
    s_add_u32 s90, s79, 2048
    buffer_load_dwordx4 v[192:195], v29, s[40:43], s90 offen sc1
    s_add_u32 s90, s79, 34816
    buffer_load_dwordx4 v[196:199], v29, s[40:43], s90 offen sc1
    s_add_u32 s90, s79, 3072
    buffer_load_dwordx4 v[200:203], v29, s[40:43], s90 offen sc1
    s_add_u32 s90, s79, 35840
    buffer_load_dwordx4 v[204:207], v29, s[40:43], s90 offen sc1
    s_mov_b32 s78, 4194304
L_o0:
    s_waitcnt vmcnt(4)
    v_max3_u32 v6, v176, v177, v178
    v_max3_u32 v7, v179, v180, v181
    v_max3_u32 v6, v6, v182, v183
    v_max3_u32 v7, v7, v184, v185
    v_max3_u32 v6, v6, v186, v187
    v_max3_u32 v7, v7, v188, v189
    v_max3_u32 v6, v6, v190, v191
    v_max_u32 v6, v6, v7
    v_cmp_eq_u32 vcc, -1, v6
    s_cbranch_vccnz L_o0_retry
L_o0_go:
    v_mfma_f32_32x32x16_bf16 v[64:79], v[12:15], v[176:179], v[64:79]
    s_add_u32 s90, s79, 4096
    buffer_load_dwordx4 v[208:211], v29, s[40:43], s90 offen sc1
    v_mfma_f32_32x32x16_bf16 v[80:95], v[12:15], v[180:183], v[80:95]
    s_add_u32 s90, s79, 36864
    buffer_load_dwordx4 v[212:215], v29, s[40:43], s90 offen sc1
    v_mfma_f32_32x32x16_bf16 v[96:111], v[16:19], v[176:179], v[96:111]
    s_add_u32 s90, s79, 5120
    buffer_load_dwordx4 v[128:131], v29, s[40:43], s90 offen sc1
    v_mfma_f32_32x32x16_bf16 v[112:127], v[16:19], v[180:183], v[112:127]
    s_add_u32 s90, s79, 37888
    buffer_load_dwordx4 v[132:135], v29, s[40:43], s90 offen sc1
    v_mfma_f32_32x32x16_bf16 v[64:79], v[20:23], v[184:187], v[64:79]
    v_mfma_f32_32x32x16_bf16 v[80:95], v[20:23], v[188:191], v[80:95]
    s_waitcnt vmcnt(4)
    v_max3_u32 v6, v192, v193, v194
    v_max3_u32 v7, v195, v196, v197
    v_max3_u32 v6, v6, v198, v199
    v_max3_u32 v7, v7, v200, v201
    v_max3_u32 v6, v6, v202, v203
    v_max3_u32 v7, v7, v204, v205
    v_max3_u32 v6, v6, v206, v207
    v_max_u32 v6, v6, v7
    v_cmp_eq_u32 vcc, -1, v6
    v_mfma_f32_32x32x16_bf16 v[96:111], v[24:27], v[184:187], v[96:111]
    v_mfma_f32_32x32x16_bf16 v[112:127], v[24:27], v[188:191], v[112:127]
    s_cbranch_vccnz L_o1_retry
L_o1_go:
    v_mfma_f32_32x32x16_bf16 v[64:79], v[32:35], v[192:195], v[64:79]
    s_add_u32 s90, s79, 6144
    buffer_load_dwordx4 v[136:139], v29, s[40:43], s90 offen sc1
    v_mfma_f32_32x32x16_bf16 v[80:95], v[32:35], v[196:199], v[80:95]
    s_add_u32 s90, s79, 38912
    buffer_load_dwordx4 v[140:143], v29, s[40:43], s90 offen sc1
    v_mfma_f32_32x32x16_bf16 v[96:111], v[36:39], v[192:195], v[96:111]
    s_add_u32 s90, s79, 7168
    buffer_load_dwordx4 v[144:147], v29, s[40:43], s90 offen sc1
    v_mfma_f32_32x32x16_bf16 v[112:127], v[36:39], v[196:199], v[112:127]
    s_add_u32 s90, s79, 39936
    buffer_load_dwordx4 v[148:151], v29, s[40:43], s90 offen sc1
    v_mfma_f32_32x32x16_bf16 v[64:79], v[40:43], v[200:203], v[64:79]
    v_mfma_f32_32x32x16_bf16 v[80:95], v[40:43], v[204:207], v[80:95]
    s_waitcnt vmcnt(4)
    v_max3_u32 v6, v208, v209, v210
    v_max3_u32 v7, v211, v212, v213
    v_max3_u32 v6, v6, v214, v215
    v_max3_u32 v7, v7, v128, v129
    v_max3_u32 v6, v6, v130, v131
    v_max3_u32 v7, v7, v132, v133
    v_max3_u32 v6, v6, v134, v135
    v_max_u32 v6, v6, v7
    v_cmp_eq_u32 vcc, -1, v6
    v_mfma_f32_32x32x16_bf16 v[96:111], v[44:47], v[200:203], v[96:111]
    v_mfma_f32_32x32x16_bf16 v[112:127], v[44:47], v[204:207], v[112:127]
    s_cbranch_vccnz L_o2_retry
L_o2_go:
    v_mfma_f32_32x32x16_bf16 v[64:79], v[48:51], v[208:211], v[64:79]
    v_mfma_f32_32x32x16_bf16 v[80:95], v[48:51], v[212:215], v[80:95]
    v_mfma_f32_32x32x16_bf16 v[96:111], v[52:55], v[208:211], v[96:111]
    v_mfma_f32_32x32x16_bf16 v[112:127], v[52:55], v[212:215], v[112:127]
    v_mfma_f32_32x32x16_bf16 v[64:79], v[216:219], v[128:131], v[64:79]
    v_mfma_f32_32x32x16_bf16 v[80:95], v[216:219], v[132:135], v[80:95]
    s_waitcnt vmcnt(0)
    v_max3_u32 v6, v136, v137, v138
    v_max3_u32 v7, v139, v140, v141
    v_max3_u32 v6, v6, v142, v143
    v_max3_u32 v7, v7, v144, v145
    v_max3_u32 v6, v6, v146, v147
    v_max3_u32 v7, v7, v148, v149
    v_max3_u32 v6, v6, v150, v151
    v_max_u32 v6, v6, v7
    v_cmp_eq_u32 vcc, -1, v6
    v_mfma_f32_32x32x16_bf16 v[96:111], v[220:223], v[128:131], v[96:111]
    v_mfma_f32_32x32x16_bf16 v[112:127], v[220:223], v[132:135], v[112:127]
    s_cbranch_vccnz L_o3_retry
L_o3_go:
    v_mfma_f32_32x32x16_bf16 v[64:79], v[224:227], v[136:139], v[64:79]
    v_mfma_f32_32x32x16_bf16 v[64:79], v[232:235], v[144:147], v[64:79]
    s_nop 1
    s_nop 1
    v_mfma_f32_32x32x16_bf16 v[80:95], v[224:227], v[140:143], v[80:95]
    s_nop 1
    s_nop 1
    v_mfma_f32_32x32x16_bf16 v[80:95], v[232:235], v[148:151], v[80:95]
    s_nop 1
    v_cvt_pk_bf16_f32 v64, v64, v65
    v_cvt_pk_bf16_f32 v65, v66, v67
    v_cvt_pk_bf16_f32 v66, v68, v69
    v_cvt_pk_bf16_f32 v67, v70, v71
    v_mfma_f32_32x32x16_bf16 v[96:111], v[228:231], v[136:139], v[96:111]
    ds_write2_b64 v8, v[64:65], v[66:67] offset0:0 offset1:2
    v_cvt_pk_bf16_f32 v68, v72, v73
    v_cvt_pk_bf16_f32 v69, v74, v75
    v_cvt_pk_bf16_f32 v70, v76, v77
    v_cvt_pk_bf16_f32 v71, v78, v79
    v_mfma_f32_32x32x16_bf16 v[96:111], v[236:239], v[144:147], v[96:111]
    ds_write2_b64 v8, v[68:69], v[70:71] offset0:4 offset1:6
    v_cvt_pk_bf16_f32 v80, v80, v81
    v_cvt_pk_bf16_f32 v81, v82, v83
    v_cvt_pk_bf16_f32 v82, v84, v85
    v_cvt_pk_bf16_f32 v83, v86, v87
    v_mfma_f32_32x32x16_bf16 v[112:127], v[228:231], v[140:143], v[112:127]
    ds_write2_b64 v9, v[80:81], v[82:83] offset0:0 offset1:2
    v_cvt_pk_bf16_f32 v84, v88, v89
    v_cvt_pk_bf16_f32 v85, v90, v91
    v_cvt_pk_bf16_f32 v86, v92, v93
    v_cvt_pk_bf16_f32 v87, v94, v95
    v_mfma_f32_32x32x16_bf16 v[112:127], v[236:239], v[148:151], v[112:127]
    ds_write2_b64 v9, v[84:85], v[86:87] offset0:4 offset1:6
    v_cvt_pk_bf16_f32 v96, v96, v97
    v_cvt_pk_bf16_f32 v97, v98, v99
    v_cvt_pk_bf16_f32 v98, v100, v101
    v_cvt_pk_bf16_f32 v99, v102, v103
    ds_write2_b64 v8, v[96:97], v[98:99] offset0:8 offset1:10
    v_cvt_pk_bf16_f32 v100, v104, v105
    v_cvt_pk_bf16_f32 v101, v106, v107
    v_cvt_pk_bf16_f32 v102, v108, v109
    v_cvt_pk_bf16_f32 v103, v110, v111
    ds_write2_b64 v8, v[100:101], v[102:103] offset0:12 offset1:14
    s_nop 0
    v_cvt_pk_bf16_f32 v112, v112, v113
    v_cvt_pk_bf16_f32 v113, v114, v115
    v_cvt_pk_bf16_f32 v114, v116, v117
    v_cvt_pk_bf16_f32 v115, v118, v119
    ds_write2_b64 v9, v[112:113], v[114:115] offset0:8 offset1:10
    v_cvt_pk_bf16_f32 v116, v120, v121
    v_cvt_pk_bf16_f32 v117, v122, v123
    v_cvt_pk_bf16_f32 v118, v124, v125
    v_cvt_pk_bf16_f32 v119, v126, v127
    ds_write2_b64 v9, v[116:117], v[118:119] offset0:12 offset1:14
    s_waitcnt lgkmcnt(0)
    s_branch L_final
L_pm_slow:
    s_mov_b32 s78, 4194304
L_pm:
    buffer_load_dword v11, v28, s[40:43], 0 offen sc1
    s_waitcnt vmcnt(0)
    s_setprio 1
    v_cmp_eq_u32 vcc, 0, v11
    s_setprio 0
    s_bitcmp1_b32 s67, 0
    s_cselect_b32 s75, 7, 15
    s_and_b32 s74, vcc_lo, s75
    s_cbranch_scc0 L_pm_ok
    s_sub_u32 s78, s78, 1
    s_cselect_b32 s78, 0, s78
    s_cbranch_scc1 L_pm_ok
    s_sleep 4
    s_branch L_pm
L_pm_ok:
    s_branch L_pm_back
L_o0_retry:
    s_waitcnt vmcnt(0)
    s_sub_u32 s78, s78, 1
    s_cselect_b32 s78, 0, s78
    s_cbranch_scc1 L_o0_go
    s_add_u32 s90, s79, 0
    buffer_load_dwordx4 v[176:179], v29, s[40:43], s90 offen sc1
    s_add_u32 s90, s79, 32768
    buffer_load_dwordx4 v[180:183], v29, s[40:43], s90 offen sc1
    s_add_u32 s90, s79, 1024
    buffer_load_dwordx4 v[184:187], v29, s[40:43], s90 offen sc1
    s_add_u32 s90, s79, 33792
    buffer_load_dwordx4 v[188:191], v29, s[40:43], s90 offen sc1
    s_add_u32 s90, s79, 2048
    buffer_load_dwordx4 v[192:195], v29, s[40:43], s90 offen sc1
    s_add_u32 s90, s79, 34816
    buffer_load_dwordx4 v[196:199], v29, s[40:43], s90 offen sc1
    s_add_u32 s90, s79, 3072
    buffer_load_dwordx4 v[200:203], v29, s[40:43], s90 offen sc1
    s_add_u32 s90, s79, 35840
    buffer_load_dwordx4 v[204:207], v29, s[40:43], s90 offen sc1
    s_branch L_o0
L_o1:
    s_waitcnt vmcnt(4)
    v_max3_u32 v6, v192, v193, v194
    v_max3_u32 v7, v195, v196, v197
    v_max3_u32 v6, v6, v198, v199
    v_max3_u32 v7, v7, v200, v201
    v_max3_u32 v6, v6, v202, v203
    v_max3_u32 v7, v7, v204, v205
    v_max3_u32 v6, v6, v206, v207
    v_max_u32 v6, v6, v7
    v_cmp_eq_u32 vcc, -1, v6
    s_cbranch_vccz L_o1_go
    s_branch L_o1_retry
L_o1_retry:
    s_waitcnt vmcnt(0)
    s_sub_u32 s78, s78, 1
    s_cselect_b32 s78, 0, s78
    s_cbranch_scc1 L_o1_go
    s_add_u32 s90, s79, 2048
    buffer_load_dwordx4 v[192:195], v29, s[40:43], s90 offen sc1
    s_add_u32 s90, s79, 34816
    buffer_load_dwordx4 v[196:199], v29, s[40:43], s90 offen sc1
    s_add_u32 s90, s79, 3072
    buffer_load_dwordx4 v[200:203], v29, s[40:43], s90 offen sc1
    s_add_u32 s90, s79, 35840
    buffer_load_dwordx4 v[204:207], v29, s[40:43], s90 offen sc1
    s_add_u32 s90, s79, 4096
    buffer_load_dwordx4 v[208:211], v29, s[40:43], s90 offen sc1
    s_add_u32 s90, s79, 36864
    buffer_load_dwordx4 v[212:215], v29, s[40:43], s90 offen sc1
    s_add_u32 s90, s79, 5120
    buffer_load_dwordx4 v[128:131], v29, s[40:43], s90 offen sc1
    s_add_u32 s90, s79, 37888
    buffer_load_dwordx4 v[132:135], v29, s[40:43], s90 offen sc1
    s_branch L_o1
L_o2:
    s_waitcnt vmcnt(4)
    v_max3_u32 v6, v208, v209, v210
    v_max3_u32 v7, v211, v212, v213
    v_max3_u32 v6, v6, v214, v215
    v_max3_u32 v7, v7, v128, v129
    v_max3_u32 v6, v6, v130, v131
    v_max3_u32 v7, v7, v132, v133
    v_max3_u32 v6, v6, v134, v135
    v_max_u32 v6, v6, v7
    v_cmp_eq_u32 vcc, -1, v6
    s_cbranch_vccz L_o2_go
    s_branch L_o2_retry
L_o2_retry:
    s_waitcnt vmcnt(0)
    s_sub_u32 s78, s78, 1
    s_cselect_b32 s78, 0, s78
    s_cbranch_scc1 L_o2_go
    s_add_u32 s90, s79, 4096
    buffer_load_dwordx4 v[208:211], v29, s[40:43], s90 offen sc1
    s_add_u32 s90, s79, 36864
    buffer_load_dwordx4 v[212:215], v29, s[40:43], s90 offen sc1
    s_add_u32 s90, s79, 5120
    buffer_load_dwordx4 v[128:131], v29, s[40:43], s90 offen sc1
    s_add_u32 s90, s79, 37888
    buffer_load_dwordx4 v[132:135], v29, s[40:43], s90 offen sc1
    s_add_u32 s90, s79, 6144
    buffer_load_dwordx4 v[136:139], v29, s[40:43], s90 offen sc1
    s_add_u32 s90, s79, 38912
    buffer_load_dwordx4 v[140:143], v29, s[40:43], s90 offen sc1
    s_add_u32 s90, s79, 7168
    buffer_load_dwordx4 v[144:147], v29, s[40:43], s90 offen sc1
    s_add_u32 s90, s79, 39936
    buffer_load_dwordx4 v[148:151], v29, s[40:43], s90 offen sc1
    s_branch L_o2
L_o3:
    s_waitcnt vmcnt(0)
    v_max3_u32 v6, v136, v137, v138
    v_max3_u32 v7, v139, v140, v141
    v_max3_u32 v6, v6, v142, v143
    v_max3_u32 v7, v7, v144, v145
    v_max3_u32 v6, v6, v146, v147
    v_max3_u32 v7, v7, v148, v149
    v_max3_u32 v6, v6, v150, v151
    v_max_u32 v6, v6, v7
    v_cmp_eq_u32 vcc, -1, v6
    s_cbranch_vccz L_o3_go
    s_branch L_o3_retry
L_o3_retry:
    s_waitcnt vmcnt(0)
    s_sub_u32 s78, s78, 1
    s_cselect_b32 s78, 0, s78
    s_cbranch_scc1 L_o3_go
    s_add_u32 s90, s79, 6144
    buffer_load_dwordx4 v[136:139], v29, s[40:43], s90 offen sc1
    s_add_u32 s90, s79, 38912
    buffer_load_dwordx4 v[140:143], v29, s[40:43], s90 offen sc1
    s_add_u32 s90, s79, 7168
    buffer_load_dwordx4 v[144:147], v29, s[40:43], s90 offen sc1
    s_add_u32 s90, s79, 39936
    buffer_load_dwordx4 v[148:151], v29, s[40:43], s90 offen sc1
    s_branch L_o3
L_A_light:
    s_cmp_eq_u32 s71, 0
    s_cselect_b32 s32, s8, s10
    s_cselect_b32 s33, s9, s11
    s_mov_b32 s34, 25088
    s_mul_i32 s75, s66, 896
    s_mul_i32 s4, s93, 3584
    s_add_u32 s5, s4, 3584
    s_cmp_eq_u32 s5, 25088
    s_cselect_b32 s5, 0, s5
    s_add_u32 s6, s5, 3584
    s_cmp_eq_u32 s6, 25088
    s_cselect_b32 s6, 0, s6
    s_add_u32 s7, s6, 3584
    s_cmp_eq_u32 s7, 25088
    s_cselect_b32 s7, 0, s7
    s_add_u32 s8, s7, 3584
    s_cmp_eq_u32 s8, 25088
    s_cselect_b32 s8, 0, s8
    s_add_u32 s9, s8, 3584
    s_cmp_eq_u32 s9, 25088
    s_cselect_b32 s9, 0, s9
    s_add_u32 s10, s9, 3584
    s_cmp_eq_u32 s10, 25088
    s_cselect_b32 s10, 0, s10
    s_add_u32 s4, s4, s75
    s_add_u32 s5, s5, s75
    s_add_u32 s6, s6, s75
    s_add_u32 s7, s7, s75
    s_add_u32 s8, s8, s75
    s_add_u32 s9, s9, s75
    s_add_u32 s10, s10, s75
    s_add_u32 m0, s76, 114688
    s_nop 0
    buffer_load_dwordx4 v7, s[32:35], s4 offen lds
    s_add_u32 m0, s76, 118784
    s_nop 0
    buffer_load_dwordx4 v7, s[32:35], s5 offen lds
    s_add_u32 m0, s76, 122880
    s_nop 0
    buffer_load_dwordx4 v7, s[32:35], s6 offen lds
    s_add_u32 m0, s76, 126976
    s_nop 0
    buffer_load_dwordx4 v7, s[32:35], s7 offen lds
    s_add_u32 m0, s76, 131072
    s_nop 0
    buffer_load_dwordx4 v7, s[32:35], s8 offen lds
    s_add_u32 m0, s76, 135168
    s_nop 0
    buffer_load_dwordx4 v7, s[32:35], s9 offen lds
    s_add_u32 m0, s76, 139264
    s_nop 0
    buffer_load_dwordx4 v7, s[32:35], s10 offen lds
    s_load_dword s96, s[64:65], 0
    s_load_dword s97, s[64:65], 64
    s_load_dword s98, s[64:65], 128
    s_mul_i32 s11, s93, 57344
    s_add_u32 s12, s11, 57344
    s_cmp_eq_u32 s12, 401408
    s_cselect_b32 s12, 0, s12
    s_add_u32 s13, s12, 57344
    s_cmp_eq_u32 s13, 401408
    s_cselect_b32 s13, 0, s13
    s_add_u32 s14, s13, 57344
    s_cmp_eq_u32 s14, 401408
    s_cselect_b32 s14, 0, s14
    s_add_u32 s15, s14, 57344
    s_cmp_eq_u32 s15, 401408
    s_cselect_b32 s15, 0, s15
    s_add_u32 s16, s15, 57344
    s_cmp_eq_u32 s16, 401408
    s_cselect_b32 s16, 0, s16
    s_add_u32 s17, s16, 57344
    s_cmp_eq_u32 s17, 401408
    s_cselect_b32 s17, 0, s17
    s_add_u32 s11, s11, s77
    s_add_u32 s12, s12, s77
    s_add_u32 s13, s13, s77
    s_add_u32 s14, s14, s77
    s_add_u32 s15, s15, s77
    s_add_u32 s16, s16, s77
    s_add_u32 s17, s17, s77
    v_mov_b32 v64, 0
    v_mov_b32 v65, 0
    v_mov_b32 v66, 0
    v_mov_b32 v67, 0
    v_mov_b32 v68, 0
    v_mov_b32 v69, 0
    v_mov_b32 v70, 0
    v_mov_b32 v71, 0
    v_mov_b32 v72, 0
    v_mov_b32 v73, 0
    v_mov_b32 v74, 0
    v_mov_b32 v75, 0
    v_mov_b32 v76, 0
    v_mov_b32 v77, 0
    v_mov_b32 v78, 0
    v_mov_b32 v79, 0
    v_mov_b32 v80, 0
    v_mov_b32 v81, 0
    v_mov_b32 v82, 0
    v_mov_b32 v83, 0
    v_mov_b32 v84, 0
    v_mov_b32 v85, 0
    v_mov_b32 v86, 0
    v_mov_b32 v87, 0
    v_mov_b32 v88, 0
    v_mov_b32 v89, 0
    v_mov_b32 v90, 0
    v_mov_b32 v91, 0
    v_mov_b32 v92, 0
    v_mov_b32 v93, 0
    v_mov_b32 v94, 0
    v_mov_b32 v95, 0
    v_mov_b32 v96, 0
    v_mov_b32 v97, 0
    v_mov_b32 v98, 0
    v_mov_b32 v99, 0
    v_mov_b32 v100, 0
    v_mov_b32 v101, 0
    v_mov_b32 v102, 0
    v_mov_b32 v103, 0
    v_mov_b32 v104, 0
    v_mov_b32 v105, 0
    v_mov_b32 v106, 0
    v_mov_b32 v107, 0
    v_mov_b32 v108, 0
    v_mov_b32 v109, 0
    v_mov_b32 v110, 0
    v_mov_b32 v111, 0
    v_mov_b32 v112, 0
    v_mov_b32 v113, 0
    v_mov_b32 v114, 0
    v_mov_b32 v115, 0
    v_mov_b32 v116, 0
    v_mov_b32 v117, 0
    v_mov_b32 v118, 0
    v_mov_b32 v119, 0
    v_mov_b32 v120, 0
    v_mov_b32 v121, 0
    v_mov_b32 v122, 0
    v_mov_b32 v123, 0
    v_mov_b32 v124, 0
    v_mov_b32 v125, 0
    v_mov_b32 v126, 0
    v_mov_b32 v127, 0
    v_mov_b32 v48, 0
    v_mov_b32 v49, 0
    v_mov_b32 v50, 0
    v_mov_b32 v51, 0
    v_mov_b32 v52, 0
    v_mov_b32 v53, 0
    v_mov_b32 v54, 0
    v_mov_b32 v55, 0
    v_mov_b32 v46, 0
    v_mov_b32 v47, 0
    v_mov_b32 v216, 0
    v_mov_b32 v217, 0
    v_mov_b32 v218, 0
    v_mov_b32 v219, 0
    v_mov_b32 v220, 0
    v_mov_b32 v221, 0
    v_mov_b32 v222, 0
    v_mov_b32 v223, 0
    v_lshlrev_b32 v8, 4, v1
    v_mov_b32 v56, 0
    s_lshr_b32 s74, s2, 1
    s_and_b32 s74, s74, 0x7c
    s_add_u32 s74, s74, s66
    s_mul_i32 s18, s74, 12544
    v_lshlrev_b32 v9, 7, v1
    s_mul_i32 s19, s74, 7
    s_lshr_b32 s19, s19, 1
    s_mul_i32 s19, s19, 896
    v_lshrrev_b32 v14, 2, v1
    v_mul_u32_u24 v14, 896, v14
    v_and_b32 v15, 3, v1
    v_lshl_add_u32 v14, v15, 7, v14
    s_mul_i32 s74, s71, 384
    v_add_u32 v14, s74, v14
    s_barrier
    s_cmp_lg_u32 s66, 0
    s_cbranch_scc1 L_noclr
    s_lshl_b32 s74, s68, 14
    s_lshl_b32 s75, s71, 13
    s_add_u32 s74, s74, s75
    s_add_u32 s74, s74, 9961472
    v_lshlrev_b32 v4, 7, v1
    buffer_store_dword v48, v4, s[40:43], s74 offen sc1
    v_mov_b32 v4, 163836
    ds_write_b32 v4, v48
L_noclr:
    s_lshl_b32 s74, s68, 2
    s_add_u32 s74, s74, s67
    s_lshl_b32 s83, s74, 4
    s_add_u32 s83, s83, s69
    s_lshl_b32 s83, s83, 11
    s_add_u32 s83, s83, 524288
    v_mov_b32 v240, -1
    v_mov_b32 v241, -1
    v_mov_b32 v242, -1
    v_mov_b32 v243, -1
    buffer_store_dwordx4 v[240:243], v8, s[40:43], s83 offen offset:0 sc1
    buffer_store_dwordx4 v[240:243], v8, s[40:43], s83 offen offset:1024 sc1
    s_barrier
    s_waitcnt vmcnt(0) lgkmcnt(0)
    s_barrier
    s_barrier
    s_add_u32 m0, s76, 16384
    s_nop 0
    buffer_load_dwordx4 v3, s[36:39], s11 offen lds
    s_add_u32 m0, s76, 20480
    s_nop 0
    buffer_load_dwordx4 v3, s[36:39], s12 offen lds
    s_add_u32 m0, s76, 24576
    s_nop 0
    buffer_load_dwordx4 v3, s[36:39], s13 offen lds
    s_add_u32 m0, s76, 28672
    s_nop 0
    buffer_load_dwordx4 v3, s[36:39], s14 offen lds
    s_add_u32 m0, s76, 32768
    s_nop 0
    buffer_load_dwordx4 v3, s[36:39], s15 offen lds
    s_add_u32 m0, s76, 36864
    s_nop 0
    buffer_load_dwordx4 v3, s[36:39], s16 offen lds
    s_add_u32 m0, s76, 40960
    s_nop 0
    buffer_load_dwordx4 v3, s[36:39], s17 offen lds
    s_mov_b32 exec_lo, 0xffffffff
    s_mov_b32 exec_hi, 0x0
    s_add_u32 s75, s18, 0
    buffer_load_dword v228, v14, s[44:47], s75 offen
    s_mov_b64 exec, -1
    s_waitcnt vmcnt(1)
    s_mov_b32 exec_lo, 0xffffff
    s_mov_b32 exec_hi, 0x0
    s_add_u32 s75, s18, 7168
    buffer_load_dword v232, v14, s[44:47], s75 offen
    s_mov_b64 exec, 0xffff
    buffer_load_dword v235, v14, s[48:51], s19 offen
    s_mov_b64 exec, -1
    s_barrier
    s_branch L_A_join
L_G_light:
    v_add_u32 v28, 114688, v28
    s_barrier
    ds_read_b64_tr_b16 v[240:241], v28 offset:0
    ds_read_b64_tr_b16 v[242:243], v28 offset:256
    ds_read_b64_tr_b16 v[244:245], v28 offset:1024
    ds_read_b64_tr_b16 v[246:247], v28 offset:1280
    ds_read_b64_tr_b16 v[248:249], v28 offset:2048
    ds_read_b64_tr_b16 v[250:251], v28 offset:2304
    ds_read_b64_tr_b16 v[252:253], v28 offset:3072
    ds_read_b64_tr_b16 v[254:255], v28 offset:3328
    v_mov_b32 v20, v30
    v_mov_b32 v21, v30
    v_mov_b32 v22, v30
    v_mov_b32 v23, v30
    s_waitcnt lgkmcnt(6)
    v_mfma_f32_32x32x16_bf16 v[96:111], v[240:243], v[128:131], 0
    v_mfma_f32_32x32x16_bf16 v[112:127], v[240:243], v[20:23], 0
    ds_read_b64_tr_b16 v[240:241], v28 offset:4096
    ds_read_b64_tr_b16 v[242:243], v28 offset:4352
    s_waitcnt lgkmcnt(6)
    v_mfma_f32_32x32x16_bf16 v[96:111], v[244:247], v[132:135], v[96:111]
    v_mfma_f32_32x32x16_bf16 v[112:127], v[244:247], v[20:23], v[112:127]
    ds_read_b64_tr_b16 v[244:245], v28 offset:5120
    ds_read_b64_tr_b16 v[246:247], v28 offset:5376
    s_waitcnt lgkmcnt(6)
    v_mfma_f32_32x32x16_bf16 v[96:111], v[248:251], v[136:139], v[96:111]
    v_mfma_f32_32x32x16_bf16 v[112:127], v[248:251], v[20:23], v[112:127]
    ds_read_b64_tr_b16 v[248:249], v28 offset:6144
    ds_read_b64_tr_b16 v[250:251], v28 offset:6400
    s_waitcnt lgkmcnt(6)
    v_mfma_f32_32x32x16_bf16 v[96:111], v[252:255], v[140:143], v[96:111]
    v_mfma_f32_32x32x16_bf16 v[112:127], v[252:255], v[20:23], v[112:127]
    ds_read_b64_tr_b16 v[252:253], v28 offset:7168
    ds_read_b64_tr_b16 v[254:255], v28 offset:7424
    s_waitcnt lgkmcnt(6)
    v_mfma_f32_32x32x16_bf16 v[96:111], v[240:243], v[144:147], v[96:111]
    v_mfma_f32_32x32x16_bf16 v[112:127], v[240:243], v[20:23], v[112:127]
    ds_read_b64_tr_b16 v[240:241], v28 offset:8192
    ds_read_b64_tr_b16 v[242:243], v28 offset:8448
    s_waitcnt lgkmcnt(6)
    v_mfma_f32_32x32x16_bf16 v[96:111], v[244:247], v[148:151], v[96:111]
    v_mfma_f32_32x32x16_bf16 v[112:127], v[244:247], v[20:23], v[112:127]
    ds_read_b64_tr_b16 v[244:245], v28 offset:9216
    ds_read_b64_tr_b16 v[246:247], v28 offset:9472
    s_waitcnt lgkmcnt(6)
    v_mfma_f32_32x32x16_bf16 v[96:111], v[248:251], v[152:155], v[96:111]
    v_mfma_f32_32x32x16_bf16 v[112:127], v[248:251], v[20:23], v[112:127]
    ds_read_b64_tr_b16 v[248:249], v28 offset:10240
    ds_read_b64_tr_b16 v[250:251], v28 offset:10496
    s_waitcnt lgkmcnt(6)
    v_mfma_f32_32x32x16_bf16 v[96:111], v[252:255], v[156:159], v[96:111]
    v_mfma_f32_32x32x16_bf16 v[112:127], v[252:255], v[20:23], v[112:127]
    ds_read_b64_tr_b16 v[252:253], v28 offset:11264
    ds_read_b64_tr_b16 v[254:255], v28 offset:11520
    s_waitcnt lgkmcnt(6)
    v_mfma_f32_32x32x16_bf16 v[96:111], v[240:243], v[160:163], v[96:111]
    v_mfma_f32_32x32x16_bf16 v[112:127], v[240:243], v[20:23], v[112:127]
    ds_read_b64_tr_b16 v[240:241], v28 offset:12288
    ds_read_b64_tr_b16 v[242:243], v28 offset:12544
    s_waitcnt lgkmcnt(6)
    v_mfma_f32_32x32x16_bf16 v[96:111], v[244:247], v[164:167], v[96:111]
    v_mfma_f32_32x32x16_bf16 v[112:127], v[244:247], v[20:23], v[112:127]
    ds_read_b64_tr_b16 v[244:245], v28 offset:13312
    ds_read_b64_tr_b16 v[246:247], v28 offset:13568
    s_waitcnt lgkmcnt(6)
    v_mfma_f32_32x32x16_bf16 v[96:111], v[248:251], v[168:171], v[96:111]
    v_mfma_f32_32x32x16_bf16 v[112:127], v[248:251], v[20:23], v[112:127]
    ds_read_b64_tr_b16 v[248:249], v28 offset:14336
    ds_read_b64_tr_b16 v[250:251], v28 offset:14592
    s_waitcnt lgkmcnt(6)
    v_mfma_f32_32x32x16_bf16 v[96:111], v[252:255], v[172:175], v[96:111]
    v_mfma_f32_32x32x16_bf16 v[112:127], v[252:255], v[20:23], v[112:127]
    ds_read_b64_tr_b16 v[252:253], v28 offset:15360
    ds_read_b64_tr_b16 v[254:255], v28 offset:15616
    s_waitcnt lgkmcnt(6)
    v_mfma_f32_32x32x16_bf16 v[96:111], v[240:243], v[176:179], v[96:111]
    v_mfma_f32_32x32x16_bf16 v[112:127], v[240:243], v[20:23], v[112:127]
    ds_read_b64_tr_b16 v[240:241], v28 offset:16384
    ds_read_b64_tr_b16 v[242:243], v28 offset:16640
    s_waitcnt lgkmcnt(6)
    v_mfma_f32_32x32x16_bf16 v[96:111], v[244:247], v[180:183], v[96:111]
    v_mfma_f32_32x32x16_bf16 v[112:127], v[244:247], v[20:23], v[112:127]
    ds_read_b64_tr_b16 v[244:245], v28 offset:17408
    ds_read_b64_tr_b16 v[246:247], v28 offset:17664
    s_waitcnt lgkmcnt(6)
    v_mfma_f32_32x32x16_bf16 v[96:111], v[248:251], v[184:187], v[96:111]
    v_mfma_f32_32x32x16_bf16 v[112:127], v[248:251], v[20:23], v[112:127]
    ds_read_b64_tr_b16 v[248:249], v28 offset:18432
    ds_read_b64_tr_b16 v[250:251], v28 offset:18688
    s_waitcnt lgkmcnt(6)
    v_mfma_f32_32x32x16_bf16 v[96:111], v[252:255], v[188:191], v[96:111]
    v_mfma_f32_32x32x16_bf16 v[112:127], v[252:255], v[20:23], v[112:127]
    ds_read_b64_tr_b16 v[252:253], v28 offset:19456
    ds_read_b64_tr_b16 v[254:255], v28 offset:19712
    s_waitcnt lgkmcnt(6)
    v_mfma_f32_32x32x16_bf16 v[96:111], v[240:243], v[192:195], v[96:111]
    v_mfma_f32_32x32x16_bf16 v[112:127], v[240:243], v[20:23], v[112:127]
    ds_read_b64_tr_b16 v[240:241], v28 offset:20480
    ds_read_b64_tr_b16 v[242:243], v28 offset:20736
    s_waitcnt lgkmcnt(6)
    v_mfma_f32_32x32x16_bf16 v[96:111], v[244:247], v[196:199], v[96:111]
    v_mfma_f32_32x32x16_bf16 v[112:127], v[244:247], v[20:23], v[112:127]
    ds_read_b64_tr_b16 v[244:245], v28 offset:21504
    ds_read_b64_tr_b16 v[246:247], v28 offset:21760
    s_waitcnt lgkmcnt(6)
    v_mfma_f32_32x32x16_bf16 v[96:111], v[248:251], v[200:203], v[96:111]
    v_mfma_f32_32x32x16_bf16 v[112:127], v[248:251], v[20:23], v[112:127]
    ds_read_b64_tr_b16 v[248:249], v28 offset:22528
    ds_read_b64_tr_b16 v[250:251], v28 offset:22784
    s_waitcnt lgkmcnt(6)
    v_mfma_f32_32x32x16_bf16 v[96:111], v[252:255], v[204:207], v[96:111]
    v_mfma_f32_32x32x16_bf16 v[112:127], v[252:255], v[20:23], v[112:127]
    ds_read_b64_tr_b16 v[252:253], v28 offset:23552
    ds_read_b64_tr_b16 v[254:255], v28 offset:23808
    s_waitcnt lgkmcnt(6)
    v_mfma_f32_32x32x16_bf16 v[96:111], v[240:243], v[208:211], v[96:111]
    v_mfma_f32_32x32x16_bf16 v[112:127], v[240:243], v[20:23], v[112:127]
    ds_read_b64_tr_b16 v[240:241], v28 offset:24576
    ds_read_b64_tr_b16 v[242:243], v28 offset:24832
    s_waitcnt lgkmcnt(6)
    v_mfma_f32_32x32x16_bf16 v[96:111], v[244:247], v[212:215], v[96:111]
    v_mfma_f32_32x32x16_bf16 v[112:127], v[244:247], v[20:23], v[112:127]
    ds_read_b64_tr_b16 v[244:245], v28 offset:25600
    ds_read_b64_tr_b16 v[246:247], v28 offset:25856
    s_waitcnt lgkmcnt(6)
    v_mfma_f32_32x32x16_bf16 v[96:111], v[248:251], v[216:219], v[96:111]
    v_mfma_f32_32x32x16_bf16 v[112:127], v[248:251], v[20:23], v[112:127]
    ds_read_b64_tr_b16 v[248:249], v28 offset:26624
    ds_read_b64_tr_b16 v[250:251], v28 offset:26880
    s_waitcnt lgkmcnt(6)
    v_mfma_f32_32x32x16_bf16 v[96:111], v[252:255], v[220:223], v[96:111]
    v_mfma_f32_32x32x16_bf16 v[112:127], v[252:255], v[20:23], v[112:127]
    ds_read_b64_tr_b16 v[252:253], v28 offset:27648
    ds_read_b64_tr_b16 v[254:255], v28 offset:27904
    s_waitcnt lgkmcnt(6)
    v_mfma_f32_32x32x16_bf16 v[96:111], v[240:243], v[224:227], v[96:111]
    v_mfma_f32_32x32x16_bf16 v[112:127], v[240:243], v[20:23], v[112:127]
    s_waitcnt lgkmcnt(4)
    v_mfma_f32_32x32x16_bf16 v[96:111], v[244:247], v[228:231], v[96:111]
    v_mfma_f32_32x32x16_bf16 v[112:127], v[244:247], v[20:23], v[112:127]
    s_waitcnt lgkmcnt(2)
    v_mfma_f32_32x32x16_bf16 v[96:111], v[248:251], v[232:235], v[96:111]
    v_mfma_f32_32x32x16_bf16 v[112:127], v[248:251], v[20:23], v[112:127]
    s_waitcnt lgkmcnt(0)
    v_mfma_f32_32x32x16_bf16 v[96:111], v[252:255], v[236:239], v[96:111]
    v_mfma_f32_32x32x16_bf16 v[112:127], v[252:255], v[20:23], v[112:127]
    s_nop 11
    v_fma_f32 v96, -v8, v112, v96
    v_fma_f32 v97, -v8, v113, v97
    v_fma_f32 v98, -v8, v114, v98
    v_fma_f32 v99, -v8, v115, v99
    v_fma_f32 v100, -v8, v116, v100
    v_fma_f32 v101, -v8, v117, v101
    v_fma_f32 v102, -v8, v118, v102
    v_fma_f32 v103, -v8, v119, v103
    v_fma_f32 v104, -v8, v120, v104
    v_fma_f32 v105, -v8, v121, v105
    v_fma_f32 v106, -v8, v122, v106
    v_fma_f32 v107, -v8, v123, v107
    v_fma_f32 v108, -v8, v124, v108
    v_fma_f32 v109, -v8, v125, v109
    v_fma_f32 v110, -v8, v126, v110
    v_fma_f32 v111, -v8, v127, v111
L_kv_epi:
    s_lshl_b32 s75, s68, 2
    s_add_u32 s75, s75, s67
    s_lshl_b32 s76, s75, 12
    v_mov_b32 v12, v11
    v_cndmask_b32 v13, v12, 0, s[94:95]
    v_mul_f32 v96, v96, v12
    v_mul_f32 v97, v97, v12
    v_mul_f32 v98, v98, v12
    v_mul_f32 v99, v99, v12
    v_mul_f32 v100, v100, v12
    v_mul_f32 v101, v101, v12
    v_mul_f32 v102, v102, v12
    v_mul_f32 v103, v103, v12
    v_mul_f32 v104, v104, v12
    v_mul_f32 v105, v105, v12
    v_mul_f32 v106, v106, v12
    v_mul_f32 v107, v107, v12
    v_mul_f32 v108, v108, v13
    v_mul_f32 v109, v109, v13
    v_mul_f32 v110, v110, v13
    v_mul_f32 v111, v111, v13
    s_cmp_eq_u32 s71, 1
    s_cbranch_scc1 L_v_epi
    v_cvt_pk_bf16_f32 v32, v96, v97
    v_cvt_pk_bf16_f32 v33, v98, v99
    v_cvt_pk_bf16_f32 v34, v100, v101
    v_cvt_pk_bf16_f32 v35, v102, v103
    v_cvt_pk_bf16_f32 v36, v104, v105
    v_cvt_pk_bf16_f32 v37, v106, v107
    v_cvt_pk_bf16_f32 v38, v108, v109
    v_cvt_pk_bf16_f32 v39, v110, v111
    v_cndmask_b32 v38, v38, v30, s[94:95]
    v_mul_f32 v14, v96, v96
    v_mul_f32 v15, v97, v97
    v_fmac_f32 v14, v98, v98
    v_fmac_f32 v15, v99, v99
    v_fmac_f32 v14, v100, v100
    v_fmac_f32 v15, v101, v101
    v_fmac_f32 v14, v102, v102
    v_fmac_f32 v15, v103, v103
    v_fmac_f32 v14, v104, v104
    v_fmac_f32 v15, v105, v105
    v_fmac_f32 v14, v106, v106
    v_fmac_f32 v15, v107, v107
    v_fmac_f32 v14, v108, v108
    v_fmac_f32 v15, v109, v109
    v_fmac_f32 v14, v110, v110
    v_fmac_f32 v15, v111, v111
    v_add_f32 v14, v14, v15
    v_mov_b32 v15, v14
    s_nop 1
    v_permlane32_swap_b32 v14, v15
    v_add_f32 v14, v14, v15
    buffer_store_dwordx4 v[32:35], v29, s[40:43], s76 offen sc1
    buffer_store_dwordx4 v[36:39], v29, s[40:43], s76 offen offset:1024 sc1
    s_nop 1
    v_max_f32_dpp v14, v14, v14 row_shr:1 row_mask:0xf bank_mask:0xf
    s_nop 1
    v_max_f32_dpp v14, v14, v14 row_shr:2 row_mask:0xf bank_mask:0xf
    s_nop 1
    v_max_f32_dpp v14, v14, v14 row_shr:4 row_mask:0xf bank_mask:0xf
    s_nop 1
    v_max_f32_dpp v14, v14, v14 row_shr:8 row_mask:0xf bank_mask:0xf
    s_nop 1
    v_max_f32_dpp v14, v14, v14 row_bcast:15 row_mask:0xa bank_mask:0xf
    s_nop 1
    v_max_f32_dpp v14, v14, v14 row_bcast:31 row_mask:0xc bank_mask:0xf
    s_nop 1
    v_readlane_b32 s77, v14, 63
    s_lshl_b32 s75, s75, 2
    s_add_u32 s75, s75, 262144
    v_mov_b32 v6, 0
    v_mov_b32 v7, s77
    s_mov_b64 exec, 1
    buffer_store_dword v7, v6, s[40:43], s75 offen sc1
    s_mov_b64 exec, -1
    s_branch L_kv_pub
L_v_epi:
    v_mov_b32 v6, 1.0
    v_cndmask_b32 v108, v108, v6, s[94:95]
    v_cvt_pk_bf16_f32 v32, v96, v97
    v_cvt_pk_bf16_f32 v33, v98, v99
    v_cvt_pk_bf16_f32 v34, v100, v101
    v_cvt_pk_bf16_f32 v35, v102, v103
    v_cvt_pk_bf16_f32 v36, v104, v105
    v_cvt_pk_bf16_f32 v37, v106, v107
    v_cvt_pk_bf16_f32 v38, v108, v109
    v_cvt_pk_bf16_f32 v39, v110, v111
    v_and_b32 v6, 31, v1
    v_lshrrev_b32 v7, 5, v1
    v_lshlrev_b32 v6, 6, v6
    v_lshl_add_u32 v6, v7, 3, v6
    s_lshl_b32 s74, s67, 11
    v_add_u32 v6, s74, v6
    ds_write_b64 v6, v[32:33] offset:0
    ds_write_b64 v6, v[34:35] offset:16
    ds_write_b64 v6, v[36:37] offset:32
    ds_write_b64 v6, v[38:39] offset:48
    v_bfe_u32 v6, v1, 2, 2
    v_lshl_add_u32 v6, v7, 2, v6
    v_lshlrev_b32 v6, 6, v6
    v_bfe_u32 v7, v1, 4, 1
    v_lshl_add_u32 v6, v7, 5, v6
    v_and_b32 v7, 3, v1
    v_lshl_add_u32 v6, v7, 3, v6
    v_add_u32 v6, s74, v6
    s_waitcnt lgkmcnt(0)
    ds_read_b64_tr_b16 v[40:41], v6 offset:0
    ds_read_b64_tr_b16 v[42:43], v6 offset:512
    ds_read_b64_tr_b16 v[44:45], v6 offset:1024
    ds_read_b64_tr_b16 v[46:47], v6 offset:1536
    s_waitcnt lgkmcnt(0)
    buffer_store_dwordx4 v[40:43], v29, s[40:43], s76 offen offset:2048 sc1
    buffer_store_dwordx4 v[44:47], v29, s[40:43], s76 offen offset:3072 sc1
L_kv_pub:
    v_mov_b32 v6, 0x00003f80
    v_mov_b32 v7, 0x3f800000
    v_sub_f32 v12, 0, v8
    v_dot2_f32_bf16 v14, v128, v6, v12
    v_dot2_f32_bf16 v15, v128, v7, v12
    v_dot2_f32_bf16 v16, v129, v6, v12
    v_dot2_f32_bf16 v17, v129, v7, v12
    v_dot2_f32_bf16 v18, v130, v6, v12
    v_dot2_f32_bf16 v19, v130, v7, v12
    v_cvt_pk_bf16_f32 v128, v14, v15
    v_dot2_f32_bf16 v14, v131, v6, v12
    v_dot2_f32_bf16 v15, v131, v7, v12
    v_cvt_pk_bf16_f32 v129, v16, v17
    v_dot2_f32_bf16 v16, v132, v6, v12
    v_dot2_f32_bf16 v17, v132, v7, v12
    v_cvt_pk_bf16_f32 v130, v18, v19
    v_dot2_f32_bf16 v18, v133, v6, v12
    v_dot2_f32_bf16 v19, v133, v7, v12
    v_cvt_pk_bf16_f32 v131, v14, v15
    v_dot2_f32_bf16 v14, v134, v6, v12
    v_dot2_f32_bf16 v15, v134, v7, v12
    v_cvt_pk_bf16_f32 v132, v16, v17
    v_dot2_f32_bf16 v16, v135, v6, v12
    v_dot2_f32_bf16 v17, v135, v7, v12
    v_cvt_pk_bf16_f32 v133, v18, v19
    v_dot2_f32_bf16 v18, v136, v6, v12
    v_dot2_f32_bf16 v19, v136, v7, v12
    v_cvt_pk_bf16_f32 v134, v14, v15
    v_dot2_f32_bf16 v14, v137, v6, v12
    v_dot2_f32_bf16 v15, v137, v7, v12
    v_cvt_pk_bf16_f32 v135, v16, v17
    v_dot2_f32_bf16 v16, v138, v6, v12
    v_dot2_f32_bf16 v17, v138, v7, v12
    v_cvt_pk_bf16_f32 v136, v18, v19
    v_dot2_f32_bf16 v18, v139, v6, v12
    v_dot2_f32_bf16 v19, v139, v7, v12
    v_cvt_pk_bf16_f32 v137, v14, v15
    v_dot2_f32_bf16 v14, v140, v6, v12
    v_dot2_f32_bf16 v15, v140, v7, v12
    v_cvt_pk_bf16_f32 v138, v16, v17
    v_dot2_f32_bf16 v16, v141, v6, v12
    v_dot2_f32_bf16 v17, v141, v7, v12
    v_cvt_pk_bf16_f32 v139, v18, v19
    v_dot2_f32_bf16 v18, v142, v6, v12
    v_dot2_f32_bf16 v19, v142, v7, v12
    v_cvt_pk_bf16_f32 v140, v14, v15
    v_dot2_f32_bf16 v14, v143, v6, v12
    v_dot2_f32_bf16 v15, v143, v7, v12
    v_cvt_pk_bf16_f32 v141, v16, v17
    v_dot2_f32_bf16 v16, v144, v6, v12
    v_dot2_f32_bf16 v17, v144, v7, v12
    v_cvt_pk_bf16_f32 v142, v18, v19
    v_dot2_f32_bf16 v18, v145, v6, v12
    v_dot2_f32_bf16 v19, v145, v7, v12
    v_cvt_pk_bf16_f32 v143, v14, v15
    v_dot2_f32_bf16 v14, v146, v6, v12
    v_dot2_f32_bf16 v15, v146, v7, v12
    v_cvt_pk_bf16_f32 v144, v16, v17
    v_dot2_f32_bf16 v16, v147, v6, v12
    v_dot2_f32_bf16 v17, v147, v7, v12
    v_cvt_pk_bf16_f32 v145, v18, v19
    v_dot2_f32_bf16 v18, v148, v6, v12
    v_dot2_f32_bf16 v19, v148, v7, v12
    v_cvt_pk_bf16_f32 v146, v14, v15
    v_dot2_f32_bf16 v14, v149, v6, v12
    v_dot2_f32_bf16 v15, v149, v7, v12
    v_cvt_pk_bf16_f32 v147, v16, v17
    v_dot2_f32_bf16 v16, v150, v6, v12
    v_dot2_f32_bf16 v17, v150, v7, v12
    v_cvt_pk_bf16_f32 v148, v18, v19
    v_dot2_f32_bf16 v18, v151, v6, v12
    v_dot2_f32_bf16 v19, v151, v7, v12
    v_cvt_pk_bf16_f32 v149, v14, v15
    v_dot2_f32_bf16 v14, v152, v6, v12
    v_dot2_f32_bf16 v15, v152, v7, v12
    v_cvt_pk_bf16_f32 v150, v16, v17
    v_dot2_f32_bf16 v16, v153, v6, v12
    v_dot2_f32_bf16 v17, v153, v7, v12
    v_cvt_pk_bf16_f32 v151, v18, v19
    v_dot2_f32_bf16 v18, v154, v6, v12
    v_dot2_f32_bf16 v19, v154, v7, v12
    v_cvt_pk_bf16_f32 v152, v14, v15
    v_dot2_f32_bf16 v14, v155, v6, v12
    v_dot2_f32_bf16 v15, v155, v7, v12
    v_cvt_pk_bf16_f32 v153, v16, v17
    v_dot2_f32_bf16 v16, v156, v6, v12
    v_dot2_f32_bf16 v17, v156, v7, v12
    v_cvt_pk_bf16_f32 v154, v18, v19
    v_dot2_f32_bf16 v18, v157, v6, v12
    v_dot2_f32_bf16 v19, v157, v7, v12
    v_cvt_pk_bf16_f32 v155, v14, v15
    v_dot2_f32_bf16 v14, v158, v6, v12
    v_dot2_f32_bf16 v15, v158, v7, v12
    v_cvt_pk_bf16_f32 v156, v16, v17
    v_dot2_f32_bf16 v16, v159, v6, v12
    v_dot2_f32_bf16 v17, v159, v7, v12
    v_cvt_pk_bf16_f32 v157, v18, v19
    v_dot2_f32_bf16 v18, v160, v6, v12
    v_dot2_f32_bf16 v19, v160, v7, v12
    v_cvt_pk_bf16_f32 v158, v14, v15
    v_dot2_f32_bf16 v14, v161, v6, v12
    v_dot2_f32_bf16 v15, v161, v7, v12
    v_cvt_pk_bf16_f32 v159, v16, v17
    v_dot2_f32_bf16 v16, v162, v6, v12
    v_dot2_f32_bf16 v17, v162, v7, v12
    v_cvt_pk_bf16_f32 v160, v18, v19
    v_dot2_f32_bf16 v18, v163, v6, v12
    v_dot2_f32_bf16 v19, v163, v7, v12
    v_cvt_pk_bf16_f32 v161, v14, v15
    v_dot2_f32_bf16 v14, v164, v6, v12
    v_dot2_f32_bf16 v15, v164, v7, v12
    v_cvt_pk_bf16_f32 v162, v16, v17
    v_dot2_f32_bf16 v16, v165, v6, v12
    v_dot2_f32_bf16 v17, v165, v7, v12
    v_cvt_pk_bf16_f32 v163, v18, v19
    v_dot2_f32_bf16 v18, v166, v6, v12
    v_dot2_f32_bf16 v19, v166, v7, v12
    v_cvt_pk_bf16_f32 v164, v14, v15
    v_dot2_f32_bf16 v14, v167, v6, v12
    v_dot2_f32_bf16 v15, v167, v7, v12
    v_cvt_pk_bf16_f32 v165, v16, v17
    v_dot2_f32_bf16 v16, v168, v6, v12
    v_dot2_f32_bf16 v17, v168, v7, v12
    v_cvt_pk_bf16_f32 v166, v18, v19
    v_dot2_f32_bf16 v18, v169, v6, v12
    v_dot2_f32_bf16 v19, v169, v7, v12
    v_cvt_pk_bf16_f32 v167, v14, v15
    v_dot2_f32_bf16 v14, v170, v6, v12
    v_dot2_f32_bf16 v15, v170, v7, v12
    v_cvt_pk_bf16_f32 v168, v16, v17
    v_dot2_f32_bf16 v16, v171, v6, v12
    v_dot2_f32_bf16 v17, v171, v7, v12
    v_cvt_pk_bf16_f32 v169, v18, v19
    v_dot2_f32_bf16 v18, v172, v6, v12
    v_dot2_f32_bf16 v19, v172, v7, v12
    v_cvt_pk_bf16_f32 v170, v14, v15
    v_dot2_f32_bf16 v14, v173, v6, v12
    v_dot2_f32_bf16 v15, v173, v7, v12
    v_cvt_pk_bf16_f32 v171, v16, v17
    v_dot2_f32_bf16 v16, v174, v6, v12
    v_dot2_f32_bf16 v17, v174, v7, v12
    v_cvt_pk_bf16_f32 v172, v18, v19
    v_dot2_f32_bf16 v18, v175, v6, v12
    v_dot2_f32_bf16 v19, v175, v7, v12
    v_cvt_pk_bf16_f32 v173, v14, v15
    v_dot2_f32_bf16 v14, v176, v6, v12
    v_dot2_f32_bf16 v15, v176, v7, v12
    v_cvt_pk_bf16_f32 v174, v16, v17
    v_dot2_f32_bf16 v16, v177, v6, v12
    v_dot2_f32_bf16 v17, v177, v7, v12
    v_cvt_pk_bf16_f32 v175, v18, v19
    v_mov_b32 v24, 163836
    v_mov_b32 v25, 1
    s_mov_b64 exec, 1
    s_waitcnt vmcnt(0)
    ds_add_rtn_u32 v26, v24, v25
    v_mov_b32 v24, 0
    s_waitcnt lgkmcnt(0)
    v_cmp_eq_u32 vcc, 3, v26
    s_cbranch_vccz L_kv_notlast
    v_mov_b32 v26, 1
    buffer_atomic_add v26, v24, s[56:59], 0 offen sc0
    s_waitcnt vmcnt(0)
    v_cmp_eq_u32 vcc, 31, v26
    s_cbranch_vccz L_kv_notlast
    buffer_store_dword v25, v24, s[56:59], 0 offen offset:128 sc1
L_kv_notlast:
    s_mov_b64 exec, -1
    s_barrier
    v_add_u32 v28, 0xfffe8000, v28
    v_dot2_f32_bf16 v18, v178, v6, v12
    v_dot2_f32_bf16 v19, v178, v7, v12
    v_cvt_pk_bf16_f32 v176, v14, v15
    v_dot2_f32_bf16 v14, v179, v6, v12
    v_dot2_f32_bf16 v15, v179, v7, v12
    v_cvt_pk_bf16_f32 v177, v16, v17
    v_dot2_f32_bf16 v16, v180, v6, v12
    v_dot2_f32_bf16 v17, v180, v7, v12
    v_cvt_pk_bf16_f32 v178, v18, v19
    v_dot2_f32_bf16 v18, v181, v6, v12
    v_dot2_f32_bf16 v19, v181, v7, v12
    v_cvt_pk_bf16_f32 v179, v14, v15
    v_dot2_f32_bf16 v14, v182, v6, v12
    v_dot2_f32_bf16 v15, v182, v7, v12
    v_cvt_pk_bf16_f32 v180, v16, v17
    v_dot2_f32_bf16 v16, v183, v6, v12
    v_dot2_f32_bf16 v17, v183, v7, v12
    v_cvt_pk_bf16_f32 v181, v18, v19
    v_dot2_f32_bf16 v18, v184, v6, v12
    v_dot2_f32_bf16 v19, v184, v7, v12
    v_cvt_pk_bf16_f32 v182, v14, v15
    v_dot2_f32_bf16 v14, v185, v6, v12
    v_dot2_f32_bf16 v15, v185, v7, v12
    v_cvt_pk_bf16_f32 v183, v16, v17
    v_dot2_f32_bf16 v16, v186, v6, v12
    v_dot2_f32_bf16 v17, v186, v7, v12
    v_cvt_pk_bf16_f32 v184, v18, v19
    v_dot2_f32_bf16 v18, v187, v6, v12
    v_dot2_f32_bf16 v19, v187, v7, v12
    v_cvt_pk_bf16_f32 v185, v14, v15
    v_dot2_f32_bf16 v14, v188, v6, v12
    v_dot2_f32_bf16 v15, v188, v7, v12
    v_cvt_pk_bf16_f32 v186, v16, v17
    v_dot2_f32_bf16 v16, v189, v6, v12
    v_dot2_f32_bf16 v17, v189, v7, v12
    v_cvt_pk_bf16_f32 v187, v18, v19
    v_dot2_f32_bf16 v18, v190, v6, v12
    v_dot2_f32_bf16 v19, v190, v7, v12
    v_cvt_pk_bf16_f32 v188, v14, v15
    v_dot2_f32_bf16 v14, v191, v6, v12
    v_dot2_f32_bf16 v15, v191, v7, v12
    v_cvt_pk_bf16_f32 v189, v16, v17
    v_dot2_f32_bf16 v16, v192, v6, v12
    v_dot2_f32_bf16 v17, v192, v7, v12
    v_cvt_pk_bf16_f32 v190, v18, v19
    v_dot2_f32_bf16 v18, v193, v6, v12
    v_dot2_f32_bf16 v19, v193, v7, v12
    v_cvt_pk_bf16_f32 v191, v14, v15
    v_dot2_f32_bf16 v14, v194, v6, v12
    v_dot2_f32_bf16 v15, v194, v7, v12
    v_cvt_pk_bf16_f32 v192, v16, v17
    v_dot2_f32_bf16 v16, v195, v6, v12
    v_dot2_f32_bf16 v17, v195, v7, v12
    v_cvt_pk_bf16_f32 v193, v18, v19
    v_dot2_f32_bf16 v18, v196, v6, v12
    v_dot2_f32_bf16 v19, v196, v7, v12
    v_cvt_pk_bf16_f32 v194, v14, v15
    v_dot2_f32_bf16 v14, v197, v6, v12
    v_dot2_f32_bf16 v15, v197, v7, v12
    v_cvt_pk_bf16_f32 v195, v16, v17
    v_dot2_f32_bf16 v16, v198, v6, v12
    v_dot2_f32_bf16 v17, v198, v7, v12
    v_cvt_pk_bf16_f32 v196, v18, v19
    v_dot2_f32_bf16 v18, v199, v6, v12
    v_dot2_f32_bf16 v19, v199, v7, v12
    v_cvt_pk_bf16_f32 v197, v14, v15
    v_dot2_f32_bf16 v14, v200, v6, v12
    v_dot2_f32_bf16 v15, v200, v7, v12
    v_cvt_pk_bf16_f32 v198, v16, v17
    v_dot2_f32_bf16 v16, v201, v6, v12
    v_dot2_f32_bf16 v17, v201, v7, v12
    v_cvt_pk_bf16_f32 v199, v18, v19
    v_dot2_f32_bf16 v18, v202, v6, v12
    v_dot2_f32_bf16 v19, v202, v7, v12
    v_cvt_pk_bf16_f32 v200, v14, v15
    v_dot2_f32_bf16 v14, v203, v6, v12
    v_dot2_f32_bf16 v15, v203, v7, v12
    v_cvt_pk_bf16_f32 v201, v16, v17
    v_dot2_f32_bf16 v16, v204, v6, v12
    v_dot2_f32_bf16 v17, v204, v7, v12
    v_cvt_pk_bf16_f32 v202, v18, v19
    v_dot2_f32_bf16 v18, v205, v6, v12
    v_dot2_f32_bf16 v19, v205, v7, v12
    v_cvt_pk_bf16_f32 v203, v14, v15
    v_dot2_f32_bf16 v14, v206, v6, v12
    v_dot2_f32_bf16 v15, v206, v7, v12
    v_cvt_pk_bf16_f32 v204, v16, v17
    v_dot2_f32_bf16 v16, v207, v6, v12
    v_dot2_f32_bf16 v17, v207, v7, v12
    v_cvt_pk_bf16_f32 v205, v18, v19
    v_dot2_f32_bf16 v18, v208, v6, v12
    v_dot2_f32_bf16 v19, v208, v7, v12
    v_cvt_pk_bf16_f32 v206, v14, v15
    v_dot2_f32_bf16 v14, v209, v6, v12
    v_dot2_f32_bf16 v15, v209, v7, v12
    v_cvt_pk_bf16_f32 v207, v16, v17
    v_dot2_f32_bf16 v16, v210, v6, v12
    v_dot2_f32_bf16 v17, v210, v7, v12
    v_cvt_pk_bf16_f32 v208, v18, v19
    v_dot2_f32_bf16 v18, v211, v6, v12
    v_dot2_f32_bf16 v19, v211, v7, v12
    v_cvt_pk_bf16_f32 v209, v14, v15
    v_dot2_f32_bf16 v14, v212, v6, v12
    v_dot2_f32_bf16 v15, v212, v7, v12
    v_cvt_pk_bf16_f32 v210, v16, v17
    v_dot2_f32_bf16 v16, v213, v6, v12
    v_dot2_f32_bf16 v17, v213, v7, v12
    v_cvt_pk_bf16_f32 v211, v18, v19
    v_dot2_f32_bf16 v18, v214, v6, v12
    v_dot2_f32_bf16 v19, v214, v7, v12
    v_cvt_pk_bf16_f32 v212, v14, v15
    v_dot2_f32_bf16 v14, v215, v6, v12
    v_dot2_f32_bf16 v15, v215, v7, v12
    v_cvt_pk_bf16_f32 v213, v16, v17
    v_dot2_f32_bf16 v16, v216, v6, v12
    v_dot2_f32_bf16 v17, v216, v7, v12
    v_cvt_pk_bf16_f32 v214, v18, v19
    v_dot2_f32_bf16 v18, v217, v6, v12
    v_dot2_f32_bf16 v19, v217, v7, v12
    v_cvt_pk_bf16_f32 v215, v14, v15
    v_dot2_f32_bf16 v14, v218, v6, v12
    v_dot2_f32_bf16 v15, v218, v7, v12
    v_cvt_pk_bf16_f32 v216, v16, v17
    v_dot2_f32_bf16 v16, v219, v6, v12
    v_dot2_f32_bf16 v17, v219, v7, v12
    v_cvt_pk_bf16_f32 v217, v18, v19
    v_dot2_f32_bf16 v18, v220, v6, v12
    v_dot2_f32_bf16 v19, v220, v7, v12
    v_cvt_pk_bf16_f32 v218, v14, v15
    v_dot2_f32_bf16 v14, v221, v6, v12
    v_dot2_f32_bf16 v15, v221, v7, v12
    v_cvt_pk_bf16_f32 v219, v16, v17
    v_dot2_f32_bf16 v16, v222, v6, v12
    v_dot2_f32_bf16 v17, v222, v7, v12
    v_cvt_pk_bf16_f32 v220, v18, v19
    v_dot2_f32_bf16 v18, v223, v6, v12
    v_dot2_f32_bf16 v19, v223, v7, v12
    v_cvt_pk_bf16_f32 v221, v14, v15
    v_dot2_f32_bf16 v14, v224, v6, v12
    v_dot2_f32_bf16 v15, v224, v7, v12
    v_cvt_pk_bf16_f32 v222, v16, v17
    v_dot2_f32_bf16 v16, v225, v6, v12
    v_dot2_f32_bf16 v17, v225, v7, v12
    v_cvt_pk_bf16_f32 v223, v18, v19
    v_dot2_f32_bf16 v18, v226, v6, v12
    v_dot2_f32_bf16 v19, v226, v7, v12
    v_cvt_pk_bf16_f32 v224, v14, v15
    v_dot2_f32_bf16 v14, v227, v6, v12
    v_dot2_f32_bf16 v15, v227, v7, v12
    v_cvt_pk_bf16_f32 v225, v16, v17
    v_dot2_f32_bf16 v16, v228, v6, v12
    v_dot2_f32_bf16 v17, v228, v7, v12
    v_cvt_pk_bf16_f32 v226, v18, v19
    v_dot2_f32_bf16 v18, v229, v6, v12
    v_dot2_f32_bf16 v19, v229, v7, v12
    v_cvt_pk_bf16_f32 v227, v14, v15
    v_dot2_f32_bf16 v14, v230, v6, v12
    v_dot2_f32_bf16 v15, v230, v7, v12
    v_cvt_pk_bf16_f32 v228, v16, v17
    v_dot2_f32_bf16 v16, v231, v6, v12
    v_dot2_f32_bf16 v17, v231, v7, v12
    v_cvt_pk_bf16_f32 v229, v18, v19
    v_dot2_f32_bf16 v18, v232, v6, v12
    v_dot2_f32_bf16 v19, v232, v7, v12
    v_cvt_pk_bf16_f32 v230, v14, v15
    v_dot2_f32_bf16 v14, v233, v6, v12
    v_dot2_f32_bf16 v15, v233, v7, v12
    v_cvt_pk_bf16_f32 v231, v16, v17
    v_dot2_f32_bf16 v16, v234, v6, v12
    v_dot2_f32_bf16 v17, v234, v7, v12
    v_cvt_pk_bf16_f32 v232, v18, v19
    v_dot2_f32_bf16 v18, v235, v6, v12
    v_dot2_f32_bf16 v19, v235, v7, v12
    v_cvt_pk_bf16_f32 v233, v14, v15
    v_dot2_f32_bf16 v14, v236, v6, v12
    v_dot2_f32_bf16 v15, v236, v7, v12
    v_cvt_pk_bf16_f32 v234, v16, v17
    v_dot2_f32_bf16 v16, v237, v6, v12
    v_dot2_f32_bf16 v17, v237, v7, v12
    v_cvt_pk_bf16_f32 v235, v18, v19
    v_dot2_f32_bf16 v18, v238, v6, v12
    v_dot2_f32_bf16 v19, v238, v7, v12
    v_cvt_pk_bf16_f32 v236, v14, v15
    v_dot2_f32_bf16 v14, v239, v6, v12
    v_dot2_f32_bf16 v15, v239, v7, v12
    v_cvt_pk_bf16_f32 v237, v16, v17
    s_nop 1
    v_cvt_pk_bf16_f32 v238, v18, v19
    s_nop 1
    v_cvt_pk_bf16_f32 v239, v14, v15
    s_barrier
    ds_read_b64_tr_b16 v[240:241], v28 offset:0
    ds_read_b64_tr_b16 v[242:243], v28 offset:256
    ds_read_b64_tr_b16 v[244:245], v28 offset:1024
    ds_read_b64_tr_b16 v[246:247], v28 offset:1280
    ds_read_b64_tr_b16 v[248:249], v28 offset:2048
    ds_read_b64_tr_b16 v[250:251], v28 offset:2304
    ds_read_b64_tr_b16 v[252:253], v28 offset:3072
    ds_read_b64_tr_b16 v[254:255], v28 offset:3328
    s_waitcnt lgkmcnt(4)
    s_branch L_qpass
L_fallback:
    s_waitcnt vmcnt(0)
    v_mov_b32 v228, 0xff800000
    v_mov_b32 v229, 0xff800000
    v_mov_b32 v230, 0xff800000
    v_mov_b32 v231, 0xff800000
    s_mov_b32 s74, 0
L_fb_loop:
    buffer_load_dwordx4 v[240:243], v8, s[40:43], s74 offen offset:0 sc1
    buffer_load_dwordx4 v[244:247], v8, s[40:43], s74 offen offset:1024 sc1
    s_waitcnt vmcnt(0)
    v_mfma_f32_32x32x16_bf16 v[16:31], v[240:243], v[128:131], 0
    v_mfma_f32_32x32x16_bf16 v[16:31], v[244:247], v[132:135], v[16:31]
    s_nop 11
    v_max3_f32 v228, v228, v16, v17
    v_max3_f32 v228, v228, v18, v19
    v_max3_f32 v228, v228, v20, v21
    v_max3_f32 v228, v228, v22, v23
    v_max3_f32 v228, v228, v24, v25
    v_max3_f32 v228, v228, v26, v27
    v_max3_f32 v228, v228, v28, v29
    v_max3_f32 v228, v228, v30, v31
    v_mfma_f32_32x32x16_bf16 v[16:31], v[240:243], v[136:139], 0
    v_mfma_f32_32x32x16_bf16 v[16:31], v[244:247], v[140:143], v[16:31]
    s_nop 11
    v_max3_f32 v229, v229, v16, v17
    v_max3_f32 v229, v229, v18, v19
    v_max3_f32 v229, v229, v20, v21
    v_max3_f32 v229, v229, v22, v23
    v_max3_f32 v229, v229, v24, v25
    v_max3_f32 v229, v229, v26, v27
    v_max3_f32 v229, v229, v28, v29
    v_max3_f32 v229, v229, v30, v31
    v_mfma_f32_32x32x16_bf16 v[16:31], v[240:243], v[144:147], 0
    v_mfma_f32_32x32x16_bf16 v[16:31], v[244:247], v[148:151], v[16:31]
    s_nop 11
    v_max3_f32 v230, v230, v16, v17
    v_max3_f32 v230, v230, v18, v19
    v_max3_f32 v230, v230, v20, v21
    v_max3_f32 v230, v230, v22, v23
    v_max3_f32 v230, v230, v24, v25
    v_max3_f32 v230, v230, v26, v27
    v_max3_f32 v230, v230, v28, v29
    v_max3_f32 v230, v230, v30, v31
    v_mfma_f32_32x32x16_bf16 v[16:31], v[240:243], v[152:155], 0
    v_mfma_f32_32x32x16_bf16 v[16:31], v[244:247], v[156:159], v[16:31]
    s_nop 11
    v_max3_f32 v231, v231, v16, v17
    v_max3_f32 v231, v231, v18, v19
    v_max3_f32 v231, v231, v20, v21
    v_max3_f32 v231, v231, v22, v23
    v_max3_f32 v231, v231, v24, v25
    v_max3_f32 v231, v231, v26, v27
    v_max3_f32 v231, v231, v28, v29
    v_max3_f32 v231, v231, v30, v31
    s_add_u32 s74, s74, 4096
    s_cmp_lt_u32 s74, 262144
    s_cbranch_scc1 L_fb_loop
    v_mov_b32 v4, v228
    s_nop 1
    v_permlane32_swap_b32 v228, v4
    v_max_f32 v228, v228, v4
    v_cvt_pk_bf16_f32 v4, -v228, -v228
    v_lshlrev_b32 v4, 16, v4
    v_sub_f32 v4, -v228, v4
    v_cvt_pk_bf16_f32 v4, -v228, v4
    v_cndmask_b32 v134, v134, v4, s[94:95]
    v_mov_b32 v4, v229
    s_nop 1
    v_permlane32_swap_b32 v229, v4
    v_max_f32 v229, v229, v4
    v_cvt_pk_bf16_f32 v4, -v229, -v229
    v_lshlrev_b32 v4, 16, v4
    v_sub_f32 v4, -v229, v4
    v_cvt_pk_bf16_f32 v4, -v229, v4
    v_cndmask_b32 v142, v142, v4, s[94:95]
    v_mov_b32 v4, v230
    s_nop 1
    v_permlane32_swap_b32 v230, v4
    v_max_f32 v230, v230, v4
    v_cvt_pk_bf16_f32 v4, -v230, -v230
    v_lshlrev_b32 v4, 16, v4
    v_sub_f32 v4, -v230, v4
    v_cvt_pk_bf16_f32 v4, -v230, v4
    v_cndmask_b32 v150, v150, v4, s[94:95]
    v_mov_b32 v4, v231
    s_nop 1
    v_permlane32_swap_b32 v231, v4
    v_max_f32 v231, v231, v4
    v_cvt_pk_bf16_f32 v4, -v231, -v231
    v_lshlrev_b32 v4, 16, v4
    v_sub_f32 v4, -v231, v4
    v_cvt_pk_bf16_f32 v4, -v231, v4
    v_cndmask_b32 v158, v158, v4, s[94:95]
    s_nop 1
    v_mfma_f32_32x32x16_bf16 v[16:31], v[160:163], v[128:131], 0
    v_mfma_f32_32x32x16_bf16 v[16:31], v[164:167], v[132:135], v[16:31]
    s_nop 11
    s_branch L_attn_loop
L_codeend:
    s_endpgm
.section .rodata,"a"
.p2align 6
.amdhsa_kernel parallel_sum__grouped_kv_mqa__glu_gated_swiglu__prompt_kernel
  .amdhsa_next_free_vgpr 256
  .amdhsa_next_free_sgpr 102
  .amdhsa_accum_offset 256
  .amdhsa_group_segment_fixed_size 0
  .amdhsa_kernarg_size 96
  .amdhsa_user_sgpr_count 2
  .amdhsa_user_sgpr_kernarg_segment_ptr 1
  .amdhsa_system_sgpr_workgroup_id_x 1
.end_amdhsa_kernel
```
